```python
import torch

def _softmax(x, axis=-1):
    return torch.softmax(x, dim=axis)
def _gelu(x):
    return torch.nn.functional.gelu(x, approximate="tanh")
def _silu(x):
    return torch.nn.functional.silu(x)
def _sigmoid(x):
    return torch.sigmoid(x)
def _layernorm(x, axis=-1, eps=1e-5):
    m = x.mean(dim=axis, keepdim=True)
    v = x.var(dim=axis, keepdim=True, unbiased=False)
    return (x - m) / torch.sqrt(v + eps)
def _scatter_add(tgt, idx, src, axis=0):
    return tgt.clone().index_add_(axis, idx, src)
def _segment_sum(src, seg, n):
    out = torch.zeros((n,) + src.shape[1:], dtype=src.dtype)
    return out.index_add_(0, seg, src)
def _pad(x, pw):
    flat = tuple(v for pair in reversed(pw) for v in pair)
    return torch.nn.functional.pad(x, flat)

kernel_name = 'gated_mix__mha_block_cached__glu_gated_bilinear__decode'

def setup_inputs():

    _w = (lambda a: (lambda t: t.to(torch.bfloat16) if t.is_floating_point() else t)(torch.as_tensor(a)))
    def _A_setup():
        B, Sq, D = 1, 1, 512
        H, Sk, Dh = 32, 8192, 128
        return {
            "x": _w((lambda *s: torch.randn(*s, dtype=torch.bfloat16) * 0.05)(B, Sq, D)),
            "k_cache": _w((lambda *s: torch.randn(*s, dtype=torch.bfloat16) * 3.2)(B, H, Sk, Dh)),
            "v_cache": _w((lambda *s: torch.randn(*s, dtype=torch.bfloat16) * 0.2)(B, H, Sk, Dh)),
            "wq": _w((lambda *s: torch.randn(*s, dtype=torch.bfloat16) * 3.2)(D, H * Dh) * (D ** -0.5)),
            "wo": _w((lambda *s: torch.randn(*s, dtype=torch.bfloat16) * 0.2)(H * Dh, D) * ((H * Dh) ** -0.5)),
        }
    _A_in = _A_setup()

    def _B_setup():
        B, S, D, F = 1, 1, 512, 1376
        return {
            "x": _w((lambda *s: torch.randn(*s, dtype=torch.bfloat16) * 0.05)(B, S, D)),
            "w_gate": _w((lambda *s: torch.randn(*s, dtype=torch.bfloat16) * 0.8)(D, F) * (D ** -0.5)),
            "w_up": _w((lambda *s: torch.randn(*s, dtype=torch.bfloat16) * 0.8)(D, F) * (D ** -0.5)),
            "w_down": _w((lambda *s: torch.randn(*s, dtype=torch.bfloat16) * 0.8)(F, D) * (F ** -0.5)),
        }
    _B_in = _B_setup()

    return {
        "A_x": _A_in["x"],
        "A_k_cache": _A_in["k_cache"],
        "A_v_cache": _A_in["v_cache"],
        "A_wq": _A_in["wq"],
        "A_wo": _A_in["wo"],
        "B_x": _B_in["x"],
        "B_w_gate": _B_in["w_gate"],
        "B_w_up": _B_in["w_up"],
        "B_w_down": _B_in["w_down"],
        "gate_w": _w((lambda *s: torch.randn(*s, dtype=torch.bfloat16) * 0.1)(512) * 16.0),
    }

def reference(A_x, A_k_cache, A_v_cache, A_wq, A_wo, B_x, B_w_gate, B_w_up, B_w_down, gate_w):
    def _A_ref(x, k_cache, v_cache, wq, wo):
        B, Sq, D = x.shape
        H, Dh = 32, 128
        q = (lambda x, *d: x.permute(*d))((x @ wq).reshape(B, Sq, H, Dh), 0, 2, 1, 3)
        scores = torch.einsum("bhqd,bhkd->bhqk", q, k_cache) * (Dh ** -0.5)
        p = _softmax(scores, axis=-1)
        o = torch.einsum("bhqk,bhkd->bhqd", p, v_cache)
        return (lambda x, *d: x.permute(*d))(o, 0, 2, 1, 3).reshape(B, Sq, H * Dh) @ wo

    def _B_ref(x, w_gate, w_up, w_down):
        g = torch.einsum("bsd,df->bsf", x, w_gate)
        u = torch.einsum("bsd,df->bsf", x, w_up)
        h = g * u
        return torch.einsum("bsf,fd->bsd", h, w_down)

    x = A_x
    g = _sigmoid((x * gate_w).sum(-1, keepdims=True))
    a = _A_ref(x, A_k_cache, A_v_cache, A_wq, A_wo)
    b = _B_ref(x, B_w_gate, B_w_up, B_w_down)
    return g * a + (1 - g) * b
```

```asm
; @launch grid=(256,1,1) block=(576,1,1) lds=8192
.amdgcn_target "amdgcn-amd-amdhsa--gfx950"
.text
.globl gated_mix__mha_block_cached__glu_gated_bilinear__decode_kernel
.p2align 8
.type gated_mix__mha_block_cached__glu_gated_bilinear__decode_kernel,@function
gated_mix__mha_block_cached__glu_gated_bilinear__decode_kernel:
    s_cmp_ge_u32 s2, 256
    s_cbranch_scc1 L_end
    v_lshrrev_b32 v2, 6, v0
    s_load_dwordx2 s[32:33], s[0:1], 8
    s_load_dwordx2 s[40:41], s[0:1], 24
    s_load_dwordx2 s[4:5], s[0:1], 0
    s_load_dwordx2 s[52:53], s[0:1], 96
    v_readfirstlane_b32 s3, v2
    v_and_b32 v1, 63, v0
    s_and_b32 s64, s2, 7
    s_lshr_b32 s67, s2, 6
    s_lshl_b32 s67, s67, 3
    s_add_u32 s64, s64, s67
    s_lshr_b32 s65, s2, 3
    s_and_b32 s65, s65, 7
    s_mov_b32 s71, 8192
    s_mov_b32 s72, 16384
    s_mov_b32 s73, 24576
    s_mov_b32 s74, 32768
    s_mov_b32 s75, 40960
    s_mov_b32 s76, 49152
    s_mov_b32 s77, 57344
    s_mov_b32 s78, 65536
    s_mov_b32 s79, 73728
    s_mov_b32 s80, 81920
    s_mov_b32 s81, 90112
    s_mov_b32 s82, 98304
    s_mov_b32 s83, 106496
    s_mov_b32 s84, 114688
    s_mov_b32 s85, 122880
    s_cmp_eq_u32 s3, 8
    s_cbranch_scc0 L_stream
    s_setprio 2
    s_mov_b32 s42, 0x400000
    s_mov_b32 s43, 0x20000
    v_lshrrev_b32 v7, 4, v1
    v_lshlrev_b32 v3, 17, v7
    v_and_b32 v8, 15, v1
    v_lshl_add_u32 v3, v8, 4, v3
    s_lshl_b32 s67, s65, 19
    s_lshl_b32 s68, s64, 8
    s_add_u32 s67, s67, s68
    v_add_u32 v3, s67, v3
    s_lshl_b32 s67, s65, 7
    v_lshlrev_b32 v9, 5, v7
    v_add_u32 v9, s67, v9
    s_waitcnt lgkmcnt(0)
    global_load_dwordx4 v[16:19], v9, s[4:5]
    global_load_dwordx4 v[20:23], v9, s[4:5] offset:16
    buffer_load_dwordx4 v[40:43], v3, s[40:43], 0 offen nt
    buffer_load_dwordx4 v[44:47], v3, s[40:43], s71 offen nt
    buffer_load_dwordx4 v[48:51], v3, s[40:43], s72 offen nt
    buffer_load_dwordx4 v[52:55], v3, s[40:43], s73 offen nt
    buffer_load_dwordx4 v[56:59], v3, s[40:43], s74 offen nt
    buffer_load_dwordx4 v[60:63], v3, s[40:43], s75 offen nt
    buffer_load_dwordx4 v[64:67], v3, s[40:43], s76 offen nt
    buffer_load_dwordx4 v[68:71], v3, s[40:43], s77 offen nt
    buffer_load_dwordx4 v[72:75], v3, s[40:43], s78 offen nt
    buffer_load_dwordx4 v[76:79], v3, s[40:43], s79 offen nt
    buffer_load_dwordx4 v[80:83], v3, s[40:43], s80 offen nt
    buffer_load_dwordx4 v[84:87], v3, s[40:43], s81 offen nt
    buffer_load_dwordx4 v[88:91], v3, s[40:43], s82 offen nt
    buffer_load_dwordx4 v[92:95], v3, s[40:43], s83 offen nt
    buffer_load_dwordx4 v[96:99], v3, s[40:43], s84 offen nt
    buffer_load_dwordx4 v[100:103], v3, s[40:43], s85 offen nt
    s_barrier
    s_branch L_service
L_stream:
    s_mov_b32 s34, 0x4000000
    s_mov_b32 s35, 0x20000
    s_lshl_b32 s67, s64, 21
    s_lshl_b32 s68, s65, 18
    s_add_u32 s67, s67, s68
    s_lshl_b32 s68, s3, 12
    s_add_u32 s67, s67, s68
    v_lshlrev_b32 v2, 4, v1
    v_add_u32 v2, s67, v2
    s_waitcnt lgkmcnt(0)
    s_barrier
    buffer_load_dwordx4 v[40:43], v2, s[32:35], 0 offen offset:0 nt
    buffer_load_dwordx4 v[44:47], v2, s[32:35], 0 offen offset:1024 nt
    buffer_load_dwordx4 v[48:51], v2, s[32:35], 0 offen offset:2048 nt
    s_load_dwordx2 s[36:37], s[0:1], 16
    s_load_dwordx2 s[44:45], s[0:1], 32
    s_load_dwordx2 s[48:49], s[0:1], 64
    s_mov_b32 s86, 131072
    s_mov_b32 s87, 163840
    s_mov_b32 s88, 196608
    s_mov_b32 s89, 229376
    s_mov_b32 s38, 0x4000000
    s_mov_b32 s39, 0x20000
    s_mov_b32 s46, 0x400000
    s_mov_b32 s47, 0x20000
    s_mov_b32 s54, 0x10000000
    s_mov_b32 s55, 0x20000
    s_and_b32 s67, s2, 7
    s_mul_i32 s68, s67, 43
    s_lshr_b32 s66, s68, 3
    s_add_u32 s68, s68, 43
    s_lshr_b32 s68, s68, 3
    s_lshr_b32 s67, s2, 5
    s_add_u32 s66, s66, s67
    s_cmp_lt_u32 s66, s68
    s_cselect_b32 s69, 1, 0
    s_lshr_b32 s67, s2, 3
    s_and_b32 s67, s67, 3
    s_lshl_b32 s66, s66, 2
    s_add_u32 s66, s66, s67
    s_cmp_eq_u32 s69, 1
    s_cselect_b32 s50, 1409024, 0
    s_mov_b32 s51, 0x20000
    v_and_b32 v7, 1, v1
    v_cmp_eq_u32 vcc, 1, v7
    v_mov_b32 v7, 0xffff
    v_mov_b32 v32, 0xffff0000
    v_cndmask_b32 v7, v7, v32, vcc
    v_bfe_u32 v32, v1, 1, 2
    v_cmp_eq_u32 vcc, 0, v32
    s_nop 1
    v_cndmask_b32 v8, 0, v7, vcc
    v_cmp_eq_u32 vcc, 1, v32
    s_nop 1
    v_cndmask_b32 v9, 0, v7, vcc
    v_cmp_eq_u32 vcc, 2, v32
    s_nop 1
    v_cndmask_b32 v10, 0, v7, vcc
    v_cmp_eq_u32 vcc, 3, v32
    s_nop 1
    v_cndmask_b32 v11, 0, v7, vcc
    s_mov_b32 s92, 0x3e0293ee
    v_lshrrev_b32 v7, 3, v1
    v_lshlrev_b32 v4, 10, v7
    v_and_b32 v7, 7, v1
    v_lshl_add_u32 v4, v7, 4, v4
    s_lshl_b32 s67, s3, 7
    v_add_u32 v4, s67, v4
    s_lshl_b32 s67, s66, 13
    v_add_u32 v5, s67, v4
    s_lshl_b32 s67, s64, 17
    v_add_u32 v4, s67, v4
    v_bfe_u32 v7, v1, 1, 2
    v_lshlrev_b32 v6, 14, v7
    v_and_b32 v7, 1, v1
    v_lshl_add_u32 v6, v7, 5, v6
    v_bfe_u32 v7, v1, 4, 1
    v_lshl_add_u32 v6, v7, 4, v6
    s_lshl_b32 s67, s3, 16
    s_lshl_b32 s68, s2, 6
    s_add_u32 s67, s67, s68
    v_add_u32 v6, s67, v6
    v_and_b32 v32, 15, v1
    v_lshlrev_b32 v32, 4, v32
    s_waitcnt lgkmcnt(0)
    s_waitcnt vmcnt(2)
    buffer_load_dwordx4 v[52:55], v2, s[32:35], 0 offen offset:3072 nt
    s_waitcnt vmcnt(2)
    buffer_load_dwordx4 v[56:59], v2, s[32:35], s74 offen offset:0 nt
    s_waitcnt vmcnt(2)
    buffer_load_dwordx4 v[60:63], v2, s[32:35], s74 offen offset:1024 nt
    s_waitcnt vmcnt(2)
    buffer_load_dwordx4 v[64:67], v2, s[32:35], s74 offen offset:2048 nt
    s_waitcnt vmcnt(2)
    buffer_load_dwordx4 v[68:71], v2, s[32:35], s74 offen offset:3072 nt
    s_waitcnt vmcnt(2)
    buffer_load_dwordx4 v[72:75], v2, s[32:35], s78 offen offset:0 nt
    s_waitcnt vmcnt(2)
    buffer_load_dwordx4 v[76:79], v2, s[32:35], s78 offen offset:1024 nt
    s_waitcnt vmcnt(2)
    buffer_load_dwordx4 v[80:83], v2, s[32:35], s78 offen offset:2048 nt
    s_waitcnt vmcnt(2)
    buffer_load_dwordx4 v[84:87], v2, s[32:35], s78 offen offset:3072 nt
    s_waitcnt vmcnt(2)
    buffer_load_dwordx4 v[88:91], v2, s[32:35], s82 offen offset:0 nt
    s_waitcnt vmcnt(2)
    buffer_load_dwordx4 v[92:95], v2, s[32:35], s82 offen offset:1024 nt
    s_waitcnt vmcnt(2)
    buffer_load_dwordx4 v[96:99], v2, s[32:35], s82 offen offset:2048 nt
    s_waitcnt vmcnt(2)
    buffer_load_dwordx4 v[100:103], v2, s[32:35], s82 offen offset:3072 nt
    s_waitcnt vmcnt(2)
    buffer_load_dwordx4 v[104:107], v2, s[32:35], s86 offen offset:0 nt
    s_waitcnt vmcnt(2)
    buffer_load_dwordx4 v[108:111], v2, s[32:35], s86 offen offset:1024 nt
    s_waitcnt vmcnt(2)
    buffer_load_dwordx4 v[112:115], v2, s[32:35], s86 offen offset:2048 nt
    s_waitcnt vmcnt(2)
    buffer_load_dwordx4 v[116:119], v2, s[32:35], s86 offen offset:3072 nt
    s_waitcnt vmcnt(2)
    buffer_load_dwordx4 v[120:123], v2, s[32:35], s87 offen offset:0 nt
    s_waitcnt vmcnt(2)
    buffer_load_dwordx4 v[124:127], v2, s[32:35], s87 offen offset:1024 nt
    s_waitcnt vmcnt(2)
    buffer_load_dwordx4 v[128:131], v2, s[32:35], s87 offen offset:2048 nt
    s_waitcnt vmcnt(2)
    buffer_load_dwordx4 v[132:135], v2, s[32:35], s87 offen offset:3072 nt
    s_waitcnt vmcnt(2)
    buffer_load_dwordx4 v[136:139], v2, s[32:35], s88 offen offset:0 nt
    s_waitcnt vmcnt(2)
    buffer_load_dwordx4 v[140:143], v2, s[32:35], s88 offen offset:1024 nt
    s_waitcnt vmcnt(2)
    buffer_load_dwordx4 v[144:147], v2, s[32:35], s88 offen offset:2048 nt
    s_waitcnt vmcnt(2)
    buffer_load_dwordx4 v[148:151], v2, s[32:35], s88 offen offset:3072 nt
    s_waitcnt vmcnt(2)
    buffer_load_dwordx4 v[152:155], v2, s[32:35], s89 offen offset:0 nt
    s_waitcnt vmcnt(2)
    buffer_load_dwordx4 v[156:159], v2, s[32:35], s89 offen offset:1024 nt
    s_waitcnt vmcnt(2)
    buffer_load_dwordx4 v[160:163], v2, s[32:35], s89 offen offset:2048 nt
    buffer_load_dwordx4 v[164:167], v2, s[32:35], s89 offen offset:3072 nt
    s_barrier
    ds_read_b128 v[12:15], v32 offset:4352
    s_waitcnt lgkmcnt(0)
    s_waitcnt vmcnt(3)
    v_dot2_f32_bf16 v32, v40, v12, 0
    v_dot2_f32_bf16 v33, v44, v12, 0
    v_dot2_f32_bf16 v34, v48, v12, 0
    v_dot2_f32_bf16 v35, v52, v12, 0
    v_dot2c_f32_bf16 v32, v41, v13
    v_dot2c_f32_bf16 v33, v45, v13
    v_dot2c_f32_bf16 v34, v49, v13
    v_dot2c_f32_bf16 v35, v53, v13
    v_dot2c_f32_bf16 v32, v42, v14
    v_dot2c_f32_bf16 v33, v46, v14
    v_dot2c_f32_bf16 v34, v50, v14
    v_dot2c_f32_bf16 v35, v54, v14
    v_dot2c_f32_bf16 v32, v43, v15
    v_dot2c_f32_bf16 v33, v47, v15
    v_dot2c_f32_bf16 v34, v51, v15
    v_dot2c_f32_bf16 v35, v55, v15
    v_add_f32_dpp v36, v32, v32 row_ror:8 row_mask:0xf bank_mask:0x3
    v_add_f32_dpp v37, v33, v33 row_ror:8 row_mask:0xf bank_mask:0x3
    s_nop 0
    v_add_f32_dpp v36, v34, v34 row_ror:8 row_mask:0xf bank_mask:0xc
    v_add_f32_dpp v37, v35, v35 row_ror:8 row_mask:0xf bank_mask:0xc
    s_nop 0
    v_add_f32_dpp v16, v36, v36 row_half_mirror row_mask:0xf bank_mask:0x5
    s_nop 1
    v_add_f32_dpp v16, v37, v37 row_half_mirror row_mask:0xf bank_mask:0xa
    s_nop 1
    v_add_f32_dpp v16, v16, v16 quad_perm:[1,0,3,2] row_mask:0xf bank_mask:0xf
    s_nop 1
    v_add_f32_dpp v16, v16, v16 quad_perm:[2,3,0,1] row_mask:0xf bank_mask:0xf
    s_waitcnt vmcnt(2)
    buffer_load_dwordx4 v[40:43], v2, s[36:39], 0 offen offset:0 nt
    buffer_load_dwordx4 v[44:47], v4, s[44:47], 0 offen nt
    v_dot2_f32_bf16 v32, v56, v12, 0
    v_dot2_f32_bf16 v33, v60, v12, 0
    v_dot2_f32_bf16 v34, v64, v12, 0
    v_dot2_f32_bf16 v35, v68, v12, 0
    v_dot2c_f32_bf16 v32, v57, v13
    v_dot2c_f32_bf16 v33, v61, v13
    v_dot2c_f32_bf16 v34, v65, v13
    v_dot2c_f32_bf16 v35, v69, v13
    v_dot2c_f32_bf16 v32, v58, v14
    v_dot2c_f32_bf16 v33, v62, v14
    v_dot2c_f32_bf16 v34, v66, v14
    v_dot2c_f32_bf16 v35, v70, v14
    v_dot2c_f32_bf16 v32, v59, v15
    v_dot2c_f32_bf16 v33, v63, v15
    v_dot2c_f32_bf16 v34, v67, v15
    v_dot2c_f32_bf16 v35, v71, v15
    v_add_f32_dpp v36, v32, v32 row_ror:8 row_mask:0xf bank_mask:0x3
    v_add_f32_dpp v37, v33, v33 row_ror:8 row_mask:0xf bank_mask:0x3
    s_nop 0
    v_add_f32_dpp v36, v34, v34 row_ror:8 row_mask:0xf bank_mask:0xc
    v_add_f32_dpp v37, v35, v35 row_ror:8 row_mask:0xf bank_mask:0xc
    s_nop 0
    v_add_f32_dpp v17, v36, v36 row_half_mirror row_mask:0xf bank_mask:0x5
    s_nop 1
    v_add_f32_dpp v17, v37, v37 row_half_mirror row_mask:0xf bank_mask:0xa
    s_nop 1
    v_add_f32_dpp v17, v17, v17 quad_perm:[1,0,3,2] row_mask:0xf bank_mask:0xf
    s_nop 1
    v_add_f32_dpp v17, v17, v17 quad_perm:[2,3,0,1] row_mask:0xf bank_mask:0xf
    s_waitcnt vmcnt(3)
    buffer_load_dwordx4 v[48:51], v2, s[36:39], 0 offen offset:1024 nt
    v_dot2_f32_bf16 v32, v72, v12, 0
    v_dot2_f32_bf16 v33, v76, v12, 0
    v_dot2_f32_bf16 v34, v80, v12, 0
    v_dot2_f32_bf16 v35, v84, v12, 0
    v_dot2c_f32_bf16 v32, v73, v13
    v_dot2c_f32_bf16 v33, v77, v13
    v_dot2c_f32_bf16 v34, v81, v13
    v_dot2c_f32_bf16 v35, v85, v13
    v_dot2c_f32_bf16 v32, v74, v14
    v_dot2c_f32_bf16 v33, v78, v14
    v_dot2c_f32_bf16 v34, v82, v14
    v_dot2c_f32_bf16 v35, v86, v14
    v_dot2c_f32_bf16 v32, v75, v15
    v_dot2c_f32_bf16 v33, v79, v15
    v_dot2c_f32_bf16 v34, v83, v15
    v_dot2c_f32_bf16 v35, v87, v15
    v_add_f32_dpp v36, v32, v32 row_ror:8 row_mask:0xf bank_mask:0x3
    v_add_f32_dpp v37, v33, v33 row_ror:8 row_mask:0xf bank_mask:0x3
    s_nop 0
    v_add_f32_dpp v36, v34, v34 row_ror:8 row_mask:0xf bank_mask:0xc
    v_add_f32_dpp v37, v35, v35 row_ror:8 row_mask:0xf bank_mask:0xc
    s_nop 0
    v_add_f32_dpp v18, v36, v36 row_half_mirror row_mask:0xf bank_mask:0x5
    s_nop 1
    v_add_f32_dpp v18, v37, v37 row_half_mirror row_mask:0xf bank_mask:0xa
    s_nop 1
    v_add_f32_dpp v18, v18, v18 quad_perm:[1,0,3,2] row_mask:0xf bank_mask:0xf
    s_nop 1
    v_add_f32_dpp v18, v18, v18 quad_perm:[2,3,0,1] row_mask:0xf bank_mask:0xf
    s_waitcnt vmcnt(3)
    buffer_load_dwordx4 v[52:55], v2, s[36:39], 0 offen offset:2048 nt
    buffer_load_dwordx4 v[56:59], v4, s[44:47], s71 offen nt
    v_dot2_f32_bf16 v32, v88, v12, 0
    v_dot2_f32_bf16 v33, v92, v12, 0
    v_dot2_f32_bf16 v34, v96, v12, 0
    v_dot2_f32_bf16 v35, v100, v12, 0
    v_dot2c_f32_bf16 v32, v89, v13
    v_dot2c_f32_bf16 v33, v93, v13
    v_dot2c_f32_bf16 v34, v97, v13
    v_dot2c_f32_bf16 v35, v101, v13
    v_dot2c_f32_bf16 v32, v90, v14
    v_dot2c_f32_bf16 v33, v94, v14
    v_dot2c_f32_bf16 v34, v98, v14
    v_dot2c_f32_bf16 v35, v102, v14
    v_dot2c_f32_bf16 v32, v91, v15
    v_dot2c_f32_bf16 v33, v95, v15
    v_dot2c_f32_bf16 v34, v99, v15
    v_dot2c_f32_bf16 v35, v103, v15
    v_add_f32_dpp v36, v32, v32 row_ror:8 row_mask:0xf bank_mask:0x3
    v_add_f32_dpp v37, v33, v33 row_ror:8 row_mask:0xf bank_mask:0x3
    s_nop 0
    v_add_f32_dpp v36, v34, v34 row_ror:8 row_mask:0xf bank_mask:0xc
    v_add_f32_dpp v37, v35, v35 row_ror:8 row_mask:0xf bank_mask:0xc
    s_nop 0
    v_add_f32_dpp v19, v36, v36 row_half_mirror row_mask:0xf bank_mask:0x5
    s_nop 1
    v_add_f32_dpp v19, v37, v37 row_half_mirror row_mask:0xf bank_mask:0xa
    s_nop 1
    v_add_f32_dpp v19, v19, v19 quad_perm:[1,0,3,2] row_mask:0xf bank_mask:0xf
    s_nop 1
    v_add_f32_dpp v19, v19, v19 quad_perm:[2,3,0,1] row_mask:0xf bank_mask:0xf
    s_waitcnt vmcnt(4)
    buffer_load_dwordx4 v[60:63], v2, s[36:39], 0 offen offset:3072 nt
    v_dot2_f32_bf16 v32, v104, v12, 0
    v_dot2_f32_bf16 v33, v108, v12, 0
    v_dot2_f32_bf16 v34, v112, v12, 0
    v_dot2_f32_bf16 v35, v116, v12, 0
    v_dot2c_f32_bf16 v32, v105, v13
    v_dot2c_f32_bf16 v33, v109, v13
    v_dot2c_f32_bf16 v34, v113, v13
    v_dot2c_f32_bf16 v35, v117, v13
    v_dot2c_f32_bf16 v32, v106, v14
    v_dot2c_f32_bf16 v33, v110, v14
    v_dot2c_f32_bf16 v34, v114, v14
    v_dot2c_f32_bf16 v35, v118, v14
    v_dot2c_f32_bf16 v32, v107, v15
    v_dot2c_f32_bf16 v33, v111, v15
    v_dot2c_f32_bf16 v34, v115, v15
    v_dot2c_f32_bf16 v35, v119, v15
    v_add_f32_dpp v36, v32, v32 row_ror:8 row_mask:0xf bank_mask:0x3
    v_add_f32_dpp v37, v33, v33 row_ror:8 row_mask:0xf bank_mask:0x3
    s_nop 0
    v_add_f32_dpp v36, v34, v34 row_ror:8 row_mask:0xf bank_mask:0xc
    v_add_f32_dpp v37, v35, v35 row_ror:8 row_mask:0xf bank_mask:0xc
    s_nop 0
    v_add_f32_dpp v20, v36, v36 row_half_mirror row_mask:0xf bank_mask:0x5
    s_nop 1
    v_add_f32_dpp v20, v37, v37 row_half_mirror row_mask:0xf bank_mask:0xa
    s_nop 1
    v_add_f32_dpp v20, v20, v20 quad_perm:[1,0,3,2] row_mask:0xf bank_mask:0xf
    s_nop 1
    v_add_f32_dpp v20, v20, v20 quad_perm:[2,3,0,1] row_mask:0xf bank_mask:0xf
    s_waitcnt vmcnt(3)
    buffer_load_dwordx4 v[64:67], v2, s[36:39], s74 offen offset:0 nt
    buffer_load_dwordx4 v[68:71], v4, s[44:47], s72 offen nt
    v_dot2_f32_bf16 v32, v120, v12, 0
    v_dot2_f32_bf16 v33, v124, v12, 0
    v_dot2_f32_bf16 v34, v128, v12, 0
    v_dot2_f32_bf16 v35, v132, v12, 0
    v_dot2c_f32_bf16 v32, v121, v13
    v_dot2c_f32_bf16 v33, v125, v13
    v_dot2c_f32_bf16 v34, v129, v13
    v_dot2c_f32_bf16 v35, v133, v13
    v_dot2c_f32_bf16 v32, v122, v14
    v_dot2c_f32_bf16 v33, v126, v14
    v_dot2c_f32_bf16 v34, v130, v14
    v_dot2c_f32_bf16 v35, v134, v14
    v_dot2c_f32_bf16 v32, v123, v15
    v_dot2c_f32_bf16 v33, v127, v15
    v_dot2c_f32_bf16 v34, v131, v15
    v_dot2c_f32_bf16 v35, v135, v15
    v_add_f32_dpp v36, v32, v32 row_ror:8 row_mask:0xf bank_mask:0x3
    v_add_f32_dpp v37, v33, v33 row_ror:8 row_mask:0xf bank_mask:0x3
    s_nop 0
    v_add_f32_dpp v36, v34, v34 row_ror:8 row_mask:0xf bank_mask:0xc
    v_add_f32_dpp v37, v35, v35 row_ror:8 row_mask:0xf bank_mask:0xc
    s_nop 0
    v_add_f32_dpp v21, v36, v36 row_half_mirror row_mask:0xf bank_mask:0x5
    s_nop 1
    v_add_f32_dpp v21, v37, v37 row_half_mirror row_mask:0xf bank_mask:0xa
    s_nop 1
    v_add_f32_dpp v21, v21, v21 quad_perm:[1,0,3,2] row_mask:0xf bank_mask:0xf
    s_nop 1
    v_add_f32_dpp v21, v21, v21 quad_perm:[2,3,0,1] row_mask:0xf bank_mask:0xf
    s_waitcnt vmcnt(4)
    buffer_load_dwordx4 v[72:75], v2, s[36:39], s74 offen offset:1024 nt
    v_dot2_f32_bf16 v32, v136, v12, 0
    v_dot2_f32_bf16 v33, v140, v12, 0
    v_dot2_f32_bf16 v34, v144, v12, 0
    v_dot2_f32_bf16 v35, v148, v12, 0
    v_dot2c_f32_bf16 v32, v137, v13
    v_dot2c_f32_bf16 v33, v141, v13
    v_dot2c_f32_bf16 v34, v145, v13
    v_dot2c_f32_bf16 v35, v149, v13
    v_dot2c_f32_bf16 v32, v138, v14
    v_dot2c_f32_bf16 v33, v142, v14
    v_dot2c_f32_bf16 v34, v146, v14
    v_dot2c_f32_bf16 v35, v150, v14
    v_dot2c_f32_bf16 v32, v139, v15
    v_dot2c_f32_bf16 v33, v143, v15
    v_dot2c_f32_bf16 v34, v147, v15
    v_dot2c_f32_bf16 v35, v151, v15
    v_add_f32_dpp v36, v32, v32 row_ror:8 row_mask:0xf bank_mask:0x3
    v_add_f32_dpp v37, v33, v33 row_ror:8 row_mask:0xf bank_mask:0x3
    s_nop 0
    v_add_f32_dpp v36, v34, v34 row_ror:8 row_mask:0xf bank_mask:0xc
    v_add_f32_dpp v37, v35, v35 row_ror:8 row_mask:0xf bank_mask:0xc
    s_nop 0
    v_add_f32_dpp v22, v36, v36 row_half_mirror row_mask:0xf bank_mask:0x5
    s_nop 1
    v_add_f32_dpp v22, v37, v37 row_half_mirror row_mask:0xf bank_mask:0xa
    s_nop 1
    v_add_f32_dpp v22, v22, v22 quad_perm:[1,0,3,2] row_mask:0xf bank_mask:0xf
    s_nop 1
    v_add_f32_dpp v22, v22, v22 quad_perm:[2,3,0,1] row_mask:0xf bank_mask:0xf
    s_waitcnt vmcnt(3)
    buffer_load_dwordx4 v[76:79], v2, s[36:39], s74 offen offset:2048 nt
    buffer_load_dwordx4 v[80:83], v4, s[44:47], s73 offen nt
    v_dot2_f32_bf16 v32, v152, v12, 0
    v_dot2_f32_bf16 v33, v156, v12, 0
    v_dot2_f32_bf16 v34, v160, v12, 0
    v_dot2_f32_bf16 v35, v164, v12, 0
    v_dot2c_f32_bf16 v32, v153, v13
    v_dot2c_f32_bf16 v33, v157, v13
    v_dot2c_f32_bf16 v34, v161, v13
    v_dot2c_f32_bf16 v35, v165, v13
    v_dot2c_f32_bf16 v32, v154, v14
    v_dot2c_f32_bf16 v33, v158, v14
    v_dot2c_f32_bf16 v34, v162, v14
    v_dot2c_f32_bf16 v35, v166, v14
    v_dot2c_f32_bf16 v32, v155, v15
    v_dot2c_f32_bf16 v33, v159, v15
    v_dot2c_f32_bf16 v34, v163, v15
    v_dot2c_f32_bf16 v35, v167, v15
    v_add_f32_dpp v36, v32, v32 row_ror:8 row_mask:0xf bank_mask:0x3
    v_add_f32_dpp v37, v33, v33 row_ror:8 row_mask:0xf bank_mask:0x3
    s_nop 0
    v_add_f32_dpp v36, v34, v34 row_ror:8 row_mask:0xf bank_mask:0xc
    v_add_f32_dpp v37, v35, v35 row_ror:8 row_mask:0xf bank_mask:0xc
    s_nop 0
    v_add_f32_dpp v23, v36, v36 row_half_mirror row_mask:0xf bank_mask:0x5
    s_nop 1
    v_add_f32_dpp v23, v37, v37 row_half_mirror row_mask:0xf bank_mask:0xa
    s_nop 1
    v_add_f32_dpp v23, v23, v23 quad_perm:[1,0,3,2] row_mask:0xf bank_mask:0xf
    s_nop 1
    v_add_f32_dpp v23, v23, v23 quad_perm:[2,3,0,1] row_mask:0xf bank_mask:0xf
    buffer_load_dwordx4 v[84:87], v2, s[36:39], s74 offen offset:3072 nt
    v_max3_f32 v32, v16, v17, v18
    v_max3_f32 v32, v32, v19, v20
    v_max3_f32 v32, v32, v21, v22
    v_max_f32 v32, v32, v23
    s_nop 1
    v_max_f32_dpp v32, v32, v32 row_ror:4 row_mask:0xf bank_mask:0xf
    s_nop 1
    v_max_f32_dpp v32, v32, v32 row_ror:8 row_mask:0xf bank_mask:0xf
    v_mov_b32 v33, v32
    s_nop 1
    v_permlane16_swap_b32 v32, v33
    s_nop 0
    v_max_f32 v32, v32, v33
    v_mov_b32 v33, v32
    s_nop 1
    v_permlane32_swap_b32 v32, v33
    s_nop 0
    v_max_f32 v32, v32, v33
    v_mul_f32 v32, s92, v32
    v_fma_f32 v16, v16, s92, -v32
    v_fma_f32 v17, v17, s92, -v32
    v_fma_f32 v18, v18, s92, -v32
    v_fma_f32 v19, v19, s92, -v32
    v_fma_f32 v20, v20, s92, -v32
    v_fma_f32 v21, v21, s92, -v32
    v_fma_f32 v22, v22, s92, -v32
    v_fma_f32 v23, v23, s92, -v32
    v_exp_f32 v16, v16
    v_exp_f32 v17, v17
    v_exp_f32 v18, v18
    v_exp_f32 v19, v19
    v_exp_f32 v20, v20
    v_exp_f32 v21, v21
    v_exp_f32 v22, v22
    v_exp_f32 v23, v23
    v_add_f32 v33, v16, v17
    v_add_f32 v33, v33, v18
    v_add_f32 v33, v33, v19
    v_add_f32 v33, v33, v20
    v_add_f32 v33, v33, v21
    v_add_f32 v33, v33, v22
    v_add_f32 v33, v33, v23
    s_nop 1
    v_add_f32_dpp v33, v33, v33 row_ror:4 row_mask:0xf bank_mask:0xf
    s_nop 1
    v_add_f32_dpp v33, v33, v33 row_ror:8 row_mask:0xf bank_mask:0xf
    v_mov_b32 v34, v33
    s_nop 1
    v_permlane16_swap_b32 v33, v34
    s_nop 0
    v_add_f32 v33, v33, v34
    v_mov_b32 v34, v33
    s_nop 1
    v_permlane32_swap_b32 v33, v34
    s_nop 0
    v_add_f32 v33, v33, v34
    v_cvt_pk_bf16_f32 v16, v16, v16
    v_cvt_pk_bf16_f32 v17, v17, v17
    v_cvt_pk_bf16_f32 v18, v18, v18
    v_cvt_pk_bf16_f32 v19, v19, v19
    v_cvt_pk_bf16_f32 v20, v20, v20
    v_cvt_pk_bf16_f32 v21, v21, v21
    v_cvt_pk_bf16_f32 v22, v22, v22
    v_cvt_pk_bf16_f32 v23, v23, v23
    s_lshl_b32 s67, s3, 3
    s_add_u32 s67, s67, 5120
    v_mov_b32 v7, s67
    v_mov_b32 v34, 5264
    v_mov_b32 v35, 1
    s_mov_b64 exec, 1
    ds_write_b64 v7, v[32:33]
    ds_add_u32 v34, v35
    s_mov_b64 exec, -1
    buffer_load_dwordx4 v[12:15], v5, s[48:51], 0 offen nt
    v_and_b32 v7, 31, v1
    v_lshlrev_b32 v7, 2, v7
    s_mul_i32 s67, s3, 544
    v_add_u32 v164, s67, v7
    v_lshrrev_b32 v7, 4, v1
    v_mul_u32_u24 v165, 1088, v7
    v_lshlrev_b32 v166, 3, v7
    v_and_b32 v7, 15, v1
    v_lshl_add_u32 v165, v7, 2, v165
    s_lshl_b32 s67, s3, 6
    v_add_u32 v165, s67, v165
    s_and_b32 s67, s3, 1
    s_lshl_b32 s67, s67, 2
    s_lshr_b32 s68, s3, 1
    s_add_u32 s67, s67, s68
    s_lshl_b32 s67, s67, 6
    s_add_u32 s67, s67, 4608
    v_lshlrev_b32 v7, 2, v7
    v_add_u32 v167, s67, v7
    v_lshrrev_b32 v7, 3, v1
    v_lshlrev_b32 v160, 6, v7
    v_lshlrev_b32 v161, 2, v7
    s_lshl_b32 s67, s2, 14
    s_lshl_b32 s68, s3, 11
    s_add_u32 s67, s67, s68
    v_lshlrev_b32 v7, 4, v1
    v_add_u32 v162, s67, v7
    v_lshrrev_b32 v7, 4, v1
    v_lshrrev_b32 v163, 1, v7
    v_and_b32 v7, 1, v7
    v_lshl_add_u32 v163, v7, 1, v163
    v_and_b32 v7, 3, v1
    v_lshl_add_u32 v163, v7, 2, v163
    s_lshl_b32 s67, s3, 6
    s_add_u32 s67, s67, 5376
    v_lshlrev_b32 v163, 2, v163
    v_add_u32 v163, s67, v163
    v_and_b32_dpp v32, v16, v8 row_newbcast:0 row_mask:0xf bank_mask:0xf
    v_and_b32_dpp v33, v16, v9 row_newbcast:0 row_mask:0xf bank_mask:0xf
    v_and_b32_dpp v34, v16, v10 row_newbcast:0 row_mask:0xf bank_mask:0xf
    v_and_b32_dpp v35, v16, v11 row_newbcast:0 row_mask:0xf bank_mask:0xf
    v_and_b32_dpp v36, v16, v8 row_newbcast:4 row_mask:0xf bank_mask:0xf
    v_and_b32_dpp v37, v16, v9 row_newbcast:4 row_mask:0xf bank_mask:0xf
    v_and_b32_dpp v38, v16, v10 row_newbcast:4 row_mask:0xf bank_mask:0xf
    v_and_b32_dpp v39, v16, v11 row_newbcast:4 row_mask:0xf bank_mask:0xf
    s_waitcnt vmcnt(12)
    v_mfma_f32_16x16x32_bf16 v[24:27], v[32:35], v[40:43], 0
    v_and_b32_dpp v32, v16, v8 row_newbcast:8 row_mask:0xf bank_mask:0xf
    v_and_b32_dpp v33, v16, v9 row_newbcast:8 row_mask:0xf bank_mask:0xf
    v_and_b32_dpp v34, v16, v10 row_newbcast:8 row_mask:0xf bank_mask:0xf
    v_and_b32_dpp v35, v16, v11 row_newbcast:8 row_mask:0xf bank_mask:0xf
    s_waitcnt vmcnt(10)
    v_mfma_f32_16x16x32_bf16 v[24:27], v[36:39], v[48:51], v[24:27]
    v_and_b32_dpp v36, v16, v8 row_newbcast:12 row_mask:0xf bank_mask:0xf
    v_and_b32_dpp v37, v16, v9 row_newbcast:12 row_mask:0xf bank_mask:0xf
    v_and_b32_dpp v38, v16, v10 row_newbcast:12 row_mask:0xf bank_mask:0xf
    v_and_b32_dpp v39, v16, v11 row_newbcast:12 row_mask:0xf bank_mask:0xf
    s_waitcnt vmcnt(9)
    v_mfma_f32_16x16x32_bf16 v[24:27], v[32:35], v[52:55], v[24:27]
    v_and_b32_dpp v32, v17, v8 row_newbcast:0 row_mask:0xf bank_mask:0xf
    v_and_b32_dpp v33, v17, v9 row_newbcast:0 row_mask:0xf bank_mask:0xf
    v_and_b32_dpp v34, v17, v10 row_newbcast:0 row_mask:0xf bank_mask:0xf
    v_and_b32_dpp v35, v17, v11 row_newbcast:0 row_mask:0xf bank_mask:0xf
    s_waitcnt vmcnt(7)
    v_mfma_f32_16x16x32_bf16 v[24:27], v[36:39], v[60:63], v[24:27]
    v_and_b32_dpp v36, v17, v8 row_newbcast:4 row_mask:0xf bank_mask:0xf
    v_and_b32_dpp v37, v17, v9 row_newbcast:4 row_mask:0xf bank_mask:0xf
    v_and_b32_dpp v38, v17, v10 row_newbcast:4 row_mask:0xf bank_mask:0xf
    v_and_b32_dpp v39, v17, v11 row_newbcast:4 row_mask:0xf bank_mask:0xf
    s_waitcnt vmcnt(6)
    v_mfma_f32_16x16x32_bf16 v[24:27], v[32:35], v[64:67], v[24:27]
    v_and_b32_dpp v32, v17, v8 row_newbcast:8 row_mask:0xf bank_mask:0xf
    v_and_b32_dpp v33, v17, v9 row_newbcast:8 row_mask:0xf bank_mask:0xf
    v_and_b32_dpp v34, v17, v10 row_newbcast:8 row_mask:0xf bank_mask:0xf
    v_and_b32_dpp v35, v17, v11 row_newbcast:8 row_mask:0xf bank_mask:0xf
    s_waitcnt vmcnt(4)
    buffer_load_dwordx4 v[88:91], v2, s[36:39], s78 offen offset:0 nt
    buffer_load_dwordx4 v[92:95], v4, s[44:47], s74 offen nt
    v_mfma_f32_16x16x32_bf16 v[24:27], v[36:39], v[72:75], v[24:27]
    v_and_b32_dpp v36, v17, v8 row_newbcast:12 row_mask:0xf bank_mask:0xf
    v_and_b32_dpp v37, v17, v9 row_newbcast:12 row_mask:0xf bank_mask:0xf
    v_and_b32_dpp v38, v17, v10 row_newbcast:12 row_mask:0xf bank_mask:0xf
    v_and_b32_dpp v39, v17, v11 row_newbcast:12 row_mask:0xf bank_mask:0xf
    s_waitcnt vmcnt(5)
    buffer_load_dwordx4 v[96:99], v2, s[36:39], s78 offen offset:1024 nt
    v_mfma_f32_16x16x32_bf16 v[24:27], v[32:35], v[76:79], v[24:27]
    v_and_b32_dpp v32, v18, v8 row_newbcast:0 row_mask:0xf bank_mask:0xf
    v_and_b32_dpp v33, v18, v9 row_newbcast:0 row_mask:0xf bank_mask:0xf
    v_and_b32_dpp v34, v18, v10 row_newbcast:0 row_mask:0xf bank_mask:0xf
    v_and_b32_dpp v35, v18, v11 row_newbcast:0 row_mask:0xf bank_mask:0xf
    s_waitcnt vmcnt(4)
    buffer_load_dwordx4 v[100:103], v2, s[36:39], s78 offen offset:2048 nt
    buffer_load_dwordx4 v[104:107], v4, s[44:47], s75 offen nt
    v_mfma_f32_16x16x32_bf16 v[24:27], v[36:39], v[84:87], v[24:27]
    v_and_b32_dpp v36, v18, v8 row_newbcast:4 row_mask:0xf bank_mask:0xf
    v_and_b32_dpp v37, v18, v9 row_newbcast:4 row_mask:0xf bank_mask:0xf
    v_and_b32_dpp v38, v18, v10 row_newbcast:4 row_mask:0xf bank_mask:0xf
    v_and_b32_dpp v39, v18, v11 row_newbcast:4 row_mask:0xf bank_mask:0xf
    s_waitcnt vmcnt(4)
    buffer_load_dwordx4 v[108:111], v2, s[36:39], s78 offen offset:3072 nt
    v_mfma_f32_16x16x32_bf16 v[24:27], v[32:35], v[88:91], v[24:27]
    v_and_b32_dpp v32, v18, v8 row_newbcast:8 row_mask:0xf bank_mask:0xf
    v_and_b32_dpp v33, v18, v9 row_newbcast:8 row_mask:0xf bank_mask:0xf
    v_and_b32_dpp v34, v18, v10 row_newbcast:8 row_mask:0xf bank_mask:0xf
    v_and_b32_dpp v35, v18, v11 row_newbcast:8 row_mask:0xf bank_mask:0xf
    s_waitcnt vmcnt(3)
    buffer_load_dwordx4 v[112:115], v2, s[36:39], s82 offen offset:0 nt
    buffer_load_dwordx4 v[116:119], v4, s[44:47], s76 offen nt
    v_mfma_f32_16x16x32_bf16 v[24:27], v[36:39], v[96:99], v[24:27]
    v_and_b32_dpp v36, v18, v8 row_newbcast:12 row_mask:0xf bank_mask:0xf
    v_and_b32_dpp v37, v18, v9 row_newbcast:12 row_mask:0xf bank_mask:0xf
    v_and_b32_dpp v38, v18, v10 row_newbcast:12 row_mask:0xf bank_mask:0xf
    v_and_b32_dpp v39, v18, v11 row_newbcast:12 row_mask:0xf bank_mask:0xf
    s_waitcnt vmcnt(4)
    buffer_load_dwordx4 v[120:123], v2, s[36:39], s82 offen offset:1024 nt
    v_mfma_f32_16x16x32_bf16 v[24:27], v[32:35], v[100:103], v[24:27]
    v_and_b32_dpp v32, v19, v8 row_newbcast:0 row_mask:0xf bank_mask:0xf
    v_and_b32_dpp v33, v19, v9 row_newbcast:0 row_mask:0xf bank_mask:0xf
    v_and_b32_dpp v34, v19, v10 row_newbcast:0 row_mask:0xf bank_mask:0xf
    v_and_b32_dpp v35, v19, v11 row_newbcast:0 row_mask:0xf bank_mask:0xf
    s_waitcnt vmcnt(3)
    buffer_load_dwordx4 v[124:127], v2, s[36:39], s82 offen offset:2048 nt
    buffer_load_dwordx4 v[128:131], v4, s[44:47], s77 offen nt
    v_mfma_f32_16x16x32_bf16 v[24:27], v[36:39], v[108:111], v[24:27]
    v_and_b32_dpp v36, v19, v8 row_newbcast:4 row_mask:0xf bank_mask:0xf
    v_and_b32_dpp v37, v19, v9 row_newbcast:4 row_mask:0xf bank_mask:0xf
    v_and_b32_dpp v38, v19, v10 row_newbcast:4 row_mask:0xf bank_mask:0xf
    v_and_b32_dpp v39, v19, v11 row_newbcast:4 row_mask:0xf bank_mask:0xf
    s_waitcnt vmcnt(4)
    buffer_load_dwordx4 v[132:135], v2, s[36:39], s82 offen offset:3072 nt
    v_mfma_f32_16x16x32_bf16 v[24:27], v[32:35], v[112:115], v[24:27]
    v_and_b32_dpp v32, v19, v8 row_newbcast:8 row_mask:0xf bank_mask:0xf
    v_and_b32_dpp v33, v19, v9 row_newbcast:8 row_mask:0xf bank_mask:0xf
    v_and_b32_dpp v34, v19, v10 row_newbcast:8 row_mask:0xf bank_mask:0xf
    v_and_b32_dpp v35, v19, v11 row_newbcast:8 row_mask:0xf bank_mask:0xf
    s_waitcnt vmcnt(3)
    buffer_load_dwordx4 v[136:139], v2, s[36:39], s86 offen offset:0 nt
    buffer_load_dwordx4 v[140:143], v4, s[44:47], s78 offen nt
    v_mfma_f32_16x16x32_bf16 v[24:27], v[36:39], v[120:123], v[24:27]
    v_and_b32_dpp v36, v19, v8 row_newbcast:12 row_mask:0xf bank_mask:0xf
    v_and_b32_dpp v37, v19, v9 row_newbcast:12 row_mask:0xf bank_mask:0xf
    v_and_b32_dpp v38, v19, v10 row_newbcast:12 row_mask:0xf bank_mask:0xf
    v_and_b32_dpp v39, v19, v11 row_newbcast:12 row_mask:0xf bank_mask:0xf
    s_waitcnt vmcnt(4)
    buffer_load_dwordx4 v[144:147], v2, s[36:39], s86 offen offset:1024 nt
    v_mfma_f32_16x16x32_bf16 v[24:27], v[32:35], v[124:127], v[24:27]
    v_and_b32_dpp v32, v20, v8 row_newbcast:0 row_mask:0xf bank_mask:0xf
    v_and_b32_dpp v33, v20, v9 row_newbcast:0 row_mask:0xf bank_mask:0xf
    v_and_b32_dpp v34, v20, v10 row_newbcast:0 row_mask:0xf bank_mask:0xf
    v_and_b32_dpp v35, v20, v11 row_newbcast:0 row_mask:0xf bank_mask:0xf
    s_waitcnt vmcnt(3)
    buffer_load_dwordx4 v[148:151], v2, s[36:39], s86 offen offset:2048 nt
    buffer_load_dwordx4 v[152:155], v4, s[44:47], s79 offen nt
    v_mfma_f32_16x16x32_bf16 v[24:27], v[36:39], v[132:135], v[24:27]
    v_and_b32_dpp v36, v20, v8 row_newbcast:4 row_mask:0xf bank_mask:0xf
    v_and_b32_dpp v37, v20, v9 row_newbcast:4 row_mask:0xf bank_mask:0xf
    v_and_b32_dpp v38, v20, v10 row_newbcast:4 row_mask:0xf bank_mask:0xf
    v_and_b32_dpp v39, v20, v11 row_newbcast:4 row_mask:0xf bank_mask:0xf
    s_waitcnt vmcnt(4)
    buffer_load_dwordx4 v[156:159], v2, s[36:39], s86 offen offset:3072 nt
    v_mfma_f32_16x16x32_bf16 v[24:27], v[32:35], v[136:139], v[24:27]
    v_and_b32_dpp v32, v20, v8 row_newbcast:8 row_mask:0xf bank_mask:0xf
    v_and_b32_dpp v33, v20, v9 row_newbcast:8 row_mask:0xf bank_mask:0xf
    v_and_b32_dpp v34, v20, v10 row_newbcast:8 row_mask:0xf bank_mask:0xf
    v_and_b32_dpp v35, v20, v11 row_newbcast:8 row_mask:0xf bank_mask:0xf
    s_waitcnt vmcnt(3)
    buffer_load_dwordx4 v[40:43], v2, s[36:39], s87 offen offset:0 nt
    buffer_load_dwordx4 v[48:51], v4, s[44:47], s80 offen nt
    v_mfma_f32_16x16x32_bf16 v[24:27], v[36:39], v[144:147], v[24:27]
    v_and_b32_dpp v36, v20, v8 row_newbcast:12 row_mask:0xf bank_mask:0xf
    v_and_b32_dpp v37, v20, v9 row_newbcast:12 row_mask:0xf bank_mask:0xf
    v_and_b32_dpp v38, v20, v10 row_newbcast:12 row_mask:0xf bank_mask:0xf
    v_and_b32_dpp v39, v20, v11 row_newbcast:12 row_mask:0xf bank_mask:0xf
    s_waitcnt vmcnt(4)
    buffer_load_dwordx4 v[52:55], v2, s[36:39], s87 offen offset:1024 nt
    v_mfma_f32_16x16x32_bf16 v[24:27], v[32:35], v[148:151], v[24:27]
    v_and_b32_dpp v32, v21, v8 row_newbcast:0 row_mask:0xf bank_mask:0xf
    v_and_b32_dpp v33, v21, v9 row_newbcast:0 row_mask:0xf bank_mask:0xf
    v_and_b32_dpp v34, v21, v10 row_newbcast:0 row_mask:0xf bank_mask:0xf
    v_and_b32_dpp v35, v21, v11 row_newbcast:0 row_mask:0xf bank_mask:0xf
    s_waitcnt vmcnt(3)
    buffer_load_dwordx4 v[60:63], v2, s[36:39], s87 offen offset:2048 nt
    buffer_load_dwordx4 v[64:67], v4, s[44:47], s81 offen nt
    v_mfma_f32_16x16x32_bf16 v[24:27], v[36:39], v[156:159], v[24:27]
    v_and_b32_dpp v36, v21, v8 row_newbcast:4 row_mask:0xf bank_mask:0xf
    v_and_b32_dpp v37, v21, v9 row_newbcast:4 row_mask:0xf bank_mask:0xf
    v_and_b32_dpp v38, v21, v10 row_newbcast:4 row_mask:0xf bank_mask:0xf
    v_and_b32_dpp v39, v21, v11 row_newbcast:4 row_mask:0xf bank_mask:0xf
    s_waitcnt vmcnt(4)
    buffer_load_dwordx4 v[72:75], v2, s[36:39], s87 offen offset:3072 nt
    v_mfma_f32_16x16x32_bf16 v[24:27], v[32:35], v[40:43], v[24:27]
    v_and_b32_dpp v32, v21, v8 row_newbcast:8 row_mask:0xf bank_mask:0xf
    v_and_b32_dpp v33, v21, v9 row_newbcast:8 row_mask:0xf bank_mask:0xf
    v_and_b32_dpp v34, v21, v10 row_newbcast:8 row_mask:0xf bank_mask:0xf
    v_and_b32_dpp v35, v21, v11 row_newbcast:8 row_mask:0xf bank_mask:0xf
    s_waitcnt vmcnt(3)
    buffer_load_dwordx4 v[76:79], v2, s[36:39], s88 offen offset:0 nt
    buffer_load_dwordx4 v[84:87], v4, s[44:47], s82 offen nt
    v_mfma_f32_16x16x32_bf16 v[24:27], v[36:39], v[52:55], v[24:27]
    v_and_b32_dpp v36, v21, v8 row_newbcast:12 row_mask:0xf bank_mask:0xf
    v_and_b32_dpp v37, v21, v9 row_newbcast:12 row_mask:0xf bank_mask:0xf
    v_and_b32_dpp v38, v21, v10 row_newbcast:12 row_mask:0xf bank_mask:0xf
    v_and_b32_dpp v39, v21, v11 row_newbcast:12 row_mask:0xf bank_mask:0xf
    s_waitcnt vmcnt(4)
    buffer_load_dwordx4 v[88:91], v2, s[36:39], s88 offen offset:1024 nt
    v_mfma_f32_16x16x32_bf16 v[24:27], v[32:35], v[60:63], v[24:27]
    v_and_b32_dpp v32, v22, v8 row_newbcast:0 row_mask:0xf bank_mask:0xf
    v_and_b32_dpp v33, v22, v9 row_newbcast:0 row_mask:0xf bank_mask:0xf
    v_and_b32_dpp v34, v22, v10 row_newbcast:0 row_mask:0xf bank_mask:0xf
    v_and_b32_dpp v35, v22, v11 row_newbcast:0 row_mask:0xf bank_mask:0xf
    s_waitcnt vmcnt(3)
    buffer_load_dwordx4 v[96:99], v2, s[36:39], s88 offen offset:2048 nt
    buffer_load_dwordx4 v[100:103], v4, s[44:47], s83 offen nt
    v_mfma_f32_16x16x32_bf16 v[24:27], v[36:39], v[72:75], v[24:27]
    v_and_b32_dpp v36, v22, v8 row_newbcast:4 row_mask:0xf bank_mask:0xf
    v_and_b32_dpp v37, v22, v9 row_newbcast:4 row_mask:0xf bank_mask:0xf
    v_and_b32_dpp v38, v22, v10 row_newbcast:4 row_mask:0xf bank_mask:0xf
    v_and_b32_dpp v39, v22, v11 row_newbcast:4 row_mask:0xf bank_mask:0xf
    s_waitcnt vmcnt(4)
    buffer_load_dwordx4 v[108:111], v2, s[36:39], s88 offen offset:3072 nt
    v_mfma_f32_16x16x32_bf16 v[24:27], v[32:35], v[76:79], v[24:27]
    v_and_b32_dpp v32, v22, v8 row_newbcast:8 row_mask:0xf bank_mask:0xf
    v_and_b32_dpp v33, v22, v9 row_newbcast:8 row_mask:0xf bank_mask:0xf
    v_and_b32_dpp v34, v22, v10 row_newbcast:8 row_mask:0xf bank_mask:0xf
    v_and_b32_dpp v35, v22, v11 row_newbcast:8 row_mask:0xf bank_mask:0xf
    s_waitcnt vmcnt(3)
    buffer_load_dwordx4 v[112:115], v2, s[36:39], s89 offen offset:0 nt
    buffer_load_dwordx4 v[120:123], v4, s[44:47], s84 offen nt
    v_mfma_f32_16x16x32_bf16 v[24:27], v[36:39], v[88:91], v[24:27]
    v_and_b32_dpp v36, v22, v8 row_newbcast:12 row_mask:0xf bank_mask:0xf
    v_and_b32_dpp v37, v22, v9 row_newbcast:12 row_mask:0xf bank_mask:0xf
    v_and_b32_dpp v38, v22, v10 row_newbcast:12 row_mask:0xf bank_mask:0xf
    v_and_b32_dpp v39, v22, v11 row_newbcast:12 row_mask:0xf bank_mask:0xf
    s_waitcnt vmcnt(4)
    buffer_load_dwordx4 v[124:127], v2, s[36:39], s89 offen offset:1024 nt
    v_mfma_f32_16x16x32_bf16 v[24:27], v[32:35], v[96:99], v[24:27]
    v_and_b32_dpp v32, v23, v8 row_newbcast:0 row_mask:0xf bank_mask:0xf
    v_and_b32_dpp v33, v23, v9 row_newbcast:0 row_mask:0xf bank_mask:0xf
    v_and_b32_dpp v34, v23, v10 row_newbcast:0 row_mask:0xf bank_mask:0xf
    v_and_b32_dpp v35, v23, v11 row_newbcast:0 row_mask:0xf bank_mask:0xf
    s_waitcnt vmcnt(3)
    buffer_load_dwordx4 v[132:135], v2, s[36:39], s89 offen offset:2048 nt
    buffer_load_dwordx4 v[136:139], v4, s[44:47], s85 offen nt
    v_mfma_f32_16x16x32_bf16 v[24:27], v[36:39], v[108:111], v[24:27]
    v_and_b32_dpp v36, v23, v8 row_newbcast:4 row_mask:0xf bank_mask:0xf
    v_and_b32_dpp v37, v23, v9 row_newbcast:4 row_mask:0xf bank_mask:0xf
    v_and_b32_dpp v38, v23, v10 row_newbcast:4 row_mask:0xf bank_mask:0xf
    v_and_b32_dpp v39, v23, v11 row_newbcast:4 row_mask:0xf bank_mask:0xf
    s_waitcnt vmcnt(4)
    buffer_load_dwordx4 v[144:147], v2, s[36:39], s89 offen offset:3072 nt
    v_mfma_f32_16x16x32_bf16 v[24:27], v[32:35], v[112:115], v[24:27]
    v_and_b32_dpp v32, v23, v8 row_newbcast:8 row_mask:0xf bank_mask:0xf
    v_and_b32_dpp v33, v23, v9 row_newbcast:8 row_mask:0xf bank_mask:0xf
    v_and_b32_dpp v34, v23, v10 row_newbcast:8 row_mask:0xf bank_mask:0xf
    v_and_b32_dpp v35, v23, v11 row_newbcast:8 row_mask:0xf bank_mask:0xf
    s_waitcnt vmcnt(3)
    v_mfma_f32_16x16x32_bf16 v[24:27], v[36:39], v[124:127], v[24:27]
    v_and_b32_dpp v36, v23, v8 row_newbcast:12 row_mask:0xf bank_mask:0xf
    v_and_b32_dpp v37, v23, v9 row_newbcast:12 row_mask:0xf bank_mask:0xf
    v_and_b32_dpp v38, v23, v10 row_newbcast:12 row_mask:0xf bank_mask:0xf
    v_and_b32_dpp v39, v23, v11 row_newbcast:12 row_mask:0xf bank_mask:0xf
    s_waitcnt vmcnt(2)
    v_mfma_f32_16x16x32_bf16 v[24:27], v[32:35], v[132:135], v[24:27]
    s_waitcnt vmcnt(0)
    v_mfma_f32_16x16x32_bf16 v[24:27], v[36:39], v[144:147], v[24:27]
    s_nop 7
    ds_write2_b32 v164, v24, v25 offset0:0 offset1:32
    ds_write2_b32 v164, v26, v27 offset0:64 offset1:96
    v_mov_b32 v37, 0
    s_waitcnt lgkmcnt(0)
    s_barrier
    ds_read2_b32 v[34:35], v165 offset0:0 offset1:136
    ds_read_b64 v[32:33], v166 offset:5184
    ds_read_b32 v2, v161 offset:5216
    ds_read_b64 v[4:5], v37 offset:5248
    s_waitcnt lgkmcnt(2)
    v_mul_f32 v34, v34, v32
    v_fmac_f32 v34, v35, v33
    v_mov_b32 v35, v34
    s_nop 1
    v_permlane16_swap_b32 v34, v35
    s_nop 0
    v_add_f32 v34, v34, v35
    v_mov_b32 v35, v34
    s_nop 1
    v_permlane32_swap_b32 v34, v35
    s_nop 0
    v_add_f32 v34, v34, v35
    v_cvt_pk_bf16_f32 v34, v34, v34
    ds_write_b32 v167, v34
    s_waitcnt lgkmcnt(1)
    v_and_b32 v36, v2, v8
    v_and_b32 v37, v2, v9
    v_and_b32 v38, v2, v10
    v_and_b32 v39, v2, v11
    s_waitcnt vmcnt(36)
    s_nop 0
    v_mfma_f32_16x16x32_bf16 v[28:31], v[36:39], v[12:15], 0
    s_waitcnt lgkmcnt(0)
    s_barrier
    ds_read_b128 v[16:19], v160 offset:4608
    ds_read_b128 v[20:23], v160 offset:4624
    ds_read_b128 v[40:43], v160 offset:4640
    ds_read_b128 v[52:55], v160 offset:4656
    s_nop 1
    v_mul_f32 v28, v5, v28
    v_mul_f32 v29, v5, v29
    v_mul_f32 v30, v5, v30
    v_mul_f32 v31, v5, v31
    s_waitcnt lgkmcnt(3)
    v_and_b32 v32, v16, v8
    v_and_b32 v33, v16, v9
    v_and_b32 v34, v16, v10
    v_and_b32 v35, v16, v11
    v_and_b32 v36, v17, v8
    v_and_b32 v37, v17, v9
    v_and_b32 v38, v17, v10
    v_and_b32 v39, v17, v11
    s_waitcnt vmcnt(47)
    v_mfma_f32_16x16x32_bf16 v[24:27], v[32:35], v[44:47], 0
    v_and_b32 v32, v18, v8
    v_and_b32 v33, v18, v9
    v_and_b32 v34, v18, v10
    v_and_b32 v35, v18, v11
    s_waitcnt vmcnt(44)
    v_mfma_f32_16x16x32_bf16 v[96:99], v[36:39], v[56:59], 0
    v_and_b32 v36, v19, v8
    v_and_b32 v37, v19, v9
    v_and_b32 v38, v19, v10
    v_and_b32 v39, v19, v11
    s_waitcnt vmcnt(41)
    v_mfma_f32_16x16x32_bf16 v[24:27], v[32:35], v[68:71], v[24:27]
    s_waitcnt lgkmcnt(2)
    v_and_b32 v32, v20, v8
    v_and_b32 v33, v20, v9
    v_and_b32 v34, v20, v10
    v_and_b32 v35, v20, v11
    s_waitcnt vmcnt(38)
    v_mfma_f32_16x16x32_bf16 v[96:99], v[36:39], v[80:83], v[96:99]
    v_and_b32 v36, v21, v8
    v_and_b32 v37, v21, v9
    v_and_b32 v38, v21, v10
    v_and_b32 v39, v21, v11
    s_waitcnt vmcnt(34)
    v_mfma_f32_16x16x32_bf16 v[24:27], v[32:35], v[92:95], v[24:27]
    v_and_b32 v32, v22, v8
    v_and_b32 v33, v22, v9
    v_and_b32 v34, v22, v10
    v_and_b32 v35, v22, v11
    s_waitcnt vmcnt(31)
    v_mfma_f32_16x16x32_bf16 v[96:99], v[36:39], v[104:107], v[96:99]
    v_and_b32 v36, v23, v8
    v_and_b32 v37, v23, v9
    v_and_b32 v38, v23, v10
    v_and_b32 v39, v23, v11
    s_waitcnt vmcnt(28)
    v_mfma_f32_16x16x32_bf16 v[24:27], v[32:35], v[116:119], v[24:27]
    s_waitcnt lgkmcnt(1)
    v_and_b32 v32, v40, v8
    v_and_b32 v33, v40, v9
    v_and_b32 v34, v40, v10
    v_and_b32 v35, v40, v11
    s_waitcnt vmcnt(25)
    v_mfma_f32_16x16x32_bf16 v[96:99], v[36:39], v[128:131], v[96:99]
    v_and_b32 v36, v41, v8
    v_and_b32 v37, v41, v9
    v_and_b32 v38, v41, v10
    v_and_b32 v39, v41, v11
    s_waitcnt vmcnt(22)
    v_mfma_f32_16x16x32_bf16 v[24:27], v[32:35], v[140:143], v[24:27]
    v_and_b32 v32, v42, v8
    v_and_b32 v33, v42, v9
    v_and_b32 v34, v42, v10
    v_and_b32 v35, v42, v11
    s_waitcnt vmcnt(19)
    v_mfma_f32_16x16x32_bf16 v[96:99], v[36:39], v[152:155], v[96:99]
    v_and_b32 v36, v43, v8
    v_and_b32 v37, v43, v9
    v_and_b32 v38, v43, v10
    v_and_b32 v39, v43, v11
    s_waitcnt vmcnt(16)
    v_mfma_f32_16x16x32_bf16 v[24:27], v[32:35], v[48:51], v[24:27]
    s_waitcnt lgkmcnt(0)
    v_and_b32 v32, v52, v8
    v_and_b32 v33, v52, v9
    v_and_b32 v34, v52, v10
    v_and_b32 v35, v52, v11
    s_waitcnt vmcnt(13)
    v_mfma_f32_16x16x32_bf16 v[96:99], v[36:39], v[64:67], v[96:99]
    v_and_b32 v36, v53, v8
    v_and_b32 v37, v53, v9
    v_and_b32 v38, v53, v10
    v_and_b32 v39, v53, v11
    s_waitcnt vmcnt(10)
    v_mfma_f32_16x16x32_bf16 v[24:27], v[32:35], v[84:87], v[24:27]
    v_and_b32 v32, v54, v8
    v_and_b32 v33, v54, v9
    v_and_b32 v34, v54, v10
    v_and_b32 v35, v54, v11
    s_waitcnt vmcnt(7)
    v_mfma_f32_16x16x32_bf16 v[96:99], v[36:39], v[100:103], v[96:99]
    v_and_b32 v36, v55, v8
    v_and_b32 v37, v55, v9
    v_and_b32 v38, v55, v10
    v_and_b32 v39, v55, v11
    s_waitcnt vmcnt(4)
    v_mfma_f32_16x16x32_bf16 v[24:27], v[32:35], v[120:123], v[24:27]
    s_waitcnt vmcnt(1)
    v_mfma_f32_16x16x32_bf16 v[96:99], v[36:39], v[136:139], v[96:99]
    s_nop 5
    v_fma_f32 v28, v4, v24, v28
    v_fma_f32 v29, v4, v25, v29
    v_fma_f32 v30, v4, v26, v30
    v_fma_f32 v31, v4, v27, v31
    v_fma_f32 v24, v4, v96, v28
    v_fma_f32 v25, v4, v97, v29
    v_fma_f32 v26, v4, v98, v30
    v_fma_f32 v27, v4, v99, v31
    v_mov_b32 v28, v24
    v_mov_b32 v29, v25
    v_mov_b32 v30, v26
    v_mov_b32 v31, v27
    v_permlane32_swap_b32 v28, v24
    v_permlane32_swap_b32 v29, v25
    v_permlane32_swap_b32 v30, v26
    v_permlane32_swap_b32 v31, v27
    v_add_f32_dpp v24, v24, v28 row_ror:8 row_mask:0xf bank_mask:0xf
    v_add_f32_dpp v25, v25, v29 row_ror:8 row_mask:0xf bank_mask:0xf
    v_add_f32_dpp v26, v26, v30 row_ror:8 row_mask:0xf bank_mask:0xf
    v_add_f32_dpp v27, v27, v31 row_ror:8 row_mask:0xf bank_mask:0xf
    v_min_u32 v24, -2, v24
    v_min_u32 v25, -2, v25
    v_min_u32 v26, -2, v26
    v_min_u32 v27, -2, v27
    s_mov_b64 exec, 0x00ff00ff
    buffer_store_dwordx4 v[24:27], v6, s[52:55], 0 offen sc1
    s_mov_b64 exec, -1
    s_cmp_ge_u32 s2, 32
    s_cbranch_scc1 L_str_end
    s_mov_b32 s67, 0
    buffer_load_dwordx4 v[60:63], v162, s[52:55], 0 offen sc1
    buffer_load_dwordx4 v[72:75], v162, s[52:55], 0 offen offset:1024 sc1
    s_sleep 6
    buffer_load_dwordx4 v[76:79], v162, s[52:55], 0 offen sc1
    buffer_load_dwordx4 v[88:91], v162, s[52:55], 0 offen offset:1024 sc1
L_cp:
    s_waitcnt vmcnt(2)
    v_max3_u32 v7, v60, v61, v62
    v_max3_u32 v7, v7, v63, v72
    v_max3_u32 v7, v7, v73, v74
    v_max_u32 v7, v7, v75
    v_cmp_eq_u32 vcc, -1, v7
    s_cbranch_vccz L_cpA
    s_mov_b64 exec, vcc
    buffer_load_dwordx4 v[60:63], v162, s[52:55], 0 offen sc1
    buffer_load_dwordx4 v[72:75], v162, s[52:55], 0 offen offset:1024 sc1
    s_mov_b64 exec, -1
    s_waitcnt vmcnt(2)
    v_max3_u32 v7, v76, v77, v78
    v_max3_u32 v7, v7, v79, v88
    v_max3_u32 v7, v7, v89, v90
    v_max_u32 v7, v7, v91
    v_cmp_eq_u32 vcc, -1, v7
    s_cbranch_vccz L_cpB
    s_mov_b64 exec, vcc
    buffer_load_dwordx4 v[76:79], v162, s[52:55], 0 offen sc1
    buffer_load_dwordx4 v[88:91], v162, s[52:55], 0 offen offset:1024 sc1
    s_mov_b64 exec, -1
    s_add_u32 s67, s67, 1
    s_cmp_gt_u32 s67, 65536
    s_cbranch_scc0 L_cp
L_cpA:
    v_add_f32 v24, v60, v72
    v_add_f32 v25, v61, v73
    v_add_f32 v26, v62, v74
    v_add_f32 v27, v63, v75
    s_branch L_cpR
L_cpB:
    v_add_f32 v24, v76, v88
    v_add_f32 v25, v77, v89
    v_add_f32 v26, v78, v90
    v_add_f32 v27, v79, v91
L_cpR:
    s_nop 1
    v_permlane32_swap_b32 v24, v25
    v_permlane32_swap_b32 v26, v27
    v_add_f32 v24, v24, v25
    v_add_f32 v26, v26, v27
    s_nop 1
    v_permlane16_swap_b32 v24, v26
    s_nop 0
    v_add_f32 v24, v24, v26
    s_nop 1
    v_add_f32_dpp v24, v24, v24 row_ror:8 row_mask:0xf bank_mask:0xf
    s_nop 1
    v_add_f32_dpp v24, v24, v24 row_ror:4 row_mask:0xf bank_mask:0xf
    ds_write_b32 v163, v24
    s_waitcnt lgkmcnt(0)
    s_barrier
L_str_end:
    s_endpgm
L_service:
    s_load_dwordx2 s[8:9], s[0:1], 72
    s_load_dwordx2 s[10:11], s[0:1], 80
    s_load_dwordx2 s[12:13], s[0:1], 88
    s_load_dwordx2 s[56:57], s[0:1], 48
    s_load_dwordx2 s[60:61], s[0:1], 56
    s_mov_b32 s54, 0x10000000
    s_mov_b32 s55, 0x20000
    s_load_dwordx2 s[36:37], s[0:1], 16
    s_load_dwordx2 s[44:45], s[0:1], 32
    s_load_dwordx2 s[48:49], s[0:1], 64
    s_lshl_b32 s67, s64, 21
    s_lshl_b32 s68, s65, 18
    s_add_u32 s67, s67, s68
    v_mov_b32 v124, s67
    s_lshl_b32 s67, s64, 17
    v_mov_b32 v125, s67
    s_waitcnt lgkmcnt(0)
    s_mov_b64 exec, 1
    global_load_dword v126, v124, s[36:37] nt
    global_load_dword v127, v125, s[44:45]
    s_mov_b64 exec, -1
    v_lshrrev_b32 v2, 2, v1
    v_lshlrev_b32 v2, 14, v2
    v_and_b32 v3, 3, v1
    v_lshl_add_u32 v2, v3, 4, v2
    s_lshl_b32 s67, s2, 6
    v_add_u32 v2, s67, v2
    v_mov_b32 v4, -1
    v_mov_b32 v5, -1
    v_mov_b32 v6, -1
    v_mov_b32 v7, -1
    s_mov_b32 s68, 0x40000
    buffer_store_dwordx4 v[4:7], v2, s[52:55], 0 offen sc1
    buffer_store_dwordx4 v[4:7], v2, s[52:55], s68 offen sc1
    s_lshl_b32 s67, s64, 3
    s_add_u32 s67, s67, s65
    s_lshl_b32 s67, s67, 3
    s_add_u32 s67, s67, 524288
    v_mov_b32 v3, s67
    s_mov_b64 exec, 1
    buffer_store_dwordx2 v[4:5], v3, s[52:55], 0 offen sc1
    s_mov_b64 exec, -1
    s_and_b32 s67, s2, 7
    s_mul_i32 s68, s67, 43
    s_lshr_b32 s66, s68, 3
    s_add_u32 s68, s68, 43
    s_lshr_b32 s68, s68, 3
    s_lshr_b32 s67, s2, 5
    s_add_u32 s66, s66, s67
    s_cmp_lt_u32 s66, s68
    s_cselect_b32 s69, 1, 0
    s_lshr_b32 s67, s2, 3
    s_and_b32 s67, s67, 3
    s_lshl_b32 s66, s66, 2
    s_add_u32 s66, s66, s67
    s_cmp_eq_u32 s69, 1
    s_cselect_b32 s67, s66, 200
    s_lshl_b32 s67, s67, 8
    s_add_u32 s67, s67, 786432
    v_lshlrev_b32 v2, 2, v1
    v_add_u32 v2, s67, v2
    s_cmp_eq_u32 s69, 1
    s_cbranch_scc0 L_nogur
    buffer_store_dword v4, v2, s[52:55], 0 offen sc1
L_nogur:
    s_lshl_b32 s67, s64, 3
    s_add_u32 s67, s67, s65
    s_lshl_b32 s67, s67, 8
    s_add_u32 s67, s67, 851968
    v_and_b32 v6, 31, v1
    v_lshlrev_b32 v6, 3, v6
    v_add_u32 v6, s67, v6
    buffer_store_dwordx2 v[4:5], v6, s[52:55], 0 offen sc1
    v_mov_b32 v10, 5264
    v_mov_b32 v11, 0
    ds_write_b32 v10, v11
    v_and_b32 v7, 1, v1
    v_cmp_eq_u32 vcc, 1, v7
    v_mov_b32 v7, 0xffff
    v_mov_b32 v32, 0xffff0000
    v_cndmask_b32 v7, v7, v32, vcc
    v_bfe_u32 v32, v1, 1, 2
    v_cmp_eq_u32 vcc, 0, v32
    s_nop 1
    v_cndmask_b32 v8, 0, v7, vcc
    v_cmp_eq_u32 vcc, 1, v32
    s_nop 1
    v_cndmask_b32 v9, 0, v7, vcc
    v_cmp_eq_u32 vcc, 2, v32
    s_nop 1
    v_cndmask_b32 v10, 0, v7, vcc
    v_cmp_eq_u32 vcc, 3, v32
    s_nop 1
    v_cndmask_b32 v11, 0, v7, vcc
    s_mov_b32 s90, 0x01000100
    s_mov_b32 s91, 0x03020302
    s_waitcnt vmcnt(22)
    v_perm_b32 v7, v16, v16, s90
    v_and_b32 v32, v7, v8
    v_and_b32 v33, v7, v9
    v_and_b32 v34, v7, v10
    v_and_b32 v35, v7, v11
    s_waitcnt vmcnt(21)
    s_nop 0
    v_mfma_f32_16x16x32_bf16 v[24:27], v[32:35], v[40:43], 0
    v_perm_b32 v7, v16, v16, s91
    v_and_b32 v36, v7, v8
    v_and_b32 v37, v7, v9
    v_and_b32 v38, v7, v10
    v_and_b32 v39, v7, v11
    s_waitcnt vmcnt(20)
    s_nop 0
    v_mfma_f32_16x16x32_bf16 v[24:27], v[36:39], v[44:47], v[24:27]
    v_perm_b32 v7, v17, v17, s90
    v_and_b32 v32, v7, v8
    v_and_b32 v33, v7, v9
    v_and_b32 v34, v7, v10
    v_and_b32 v35, v7, v11
    s_waitcnt vmcnt(19)
    s_nop 0
    v_mfma_f32_16x16x32_bf16 v[24:27], v[32:35], v[48:51], v[24:27]
    v_perm_b32 v7, v17, v17, s91
    v_and_b32 v36, v7, v8
    v_and_b32 v37, v7, v9
    v_and_b32 v38, v7, v10
    v_and_b32 v39, v7, v11
    s_waitcnt vmcnt(18)
    s_nop 0
    v_mfma_f32_16x16x32_bf16 v[24:27], v[36:39], v[52:55], v[24:27]
    v_perm_b32 v7, v18, v18, s90
    v_and_b32 v32, v7, v8
    v_and_b32 v33, v7, v9
    v_and_b32 v34, v7, v10
    v_and_b32 v35, v7, v11
    s_waitcnt vmcnt(17)
    s_nop 0
    v_mfma_f32_16x16x32_bf16 v[24:27], v[32:35], v[56:59], v[24:27]
    v_perm_b32 v7, v18, v18, s91
    v_and_b32 v36, v7, v8
    v_and_b32 v37, v7, v9
    v_and_b32 v38, v7, v10
    v_and_b32 v39, v7, v11
    s_waitcnt vmcnt(16)
    s_nop 0
    v_mfma_f32_16x16x32_bf16 v[24:27], v[36:39], v[60:63], v[24:27]
    v_perm_b32 v7, v19, v19, s90
    v_and_b32 v32, v7, v8
    v_and_b32 v33, v7, v9
    v_and_b32 v34, v7, v10
    v_and_b32 v35, v7, v11
    s_waitcnt vmcnt(15)
    s_nop 0
    v_mfma_f32_16x16x32_bf16 v[24:27], v[32:35], v[64:67], v[24:27]
    v_perm_b32 v7, v19, v19, s91
    v_and_b32 v36, v7, v8
    v_and_b32 v37, v7, v9
    v_and_b32 v38, v7, v10
    v_and_b32 v39, v7, v11
    s_waitcnt vmcnt(14)
    s_nop 0
    v_mfma_f32_16x16x32_bf16 v[24:27], v[36:39], v[68:71], v[24:27]
    v_perm_b32 v7, v20, v20, s90
    v_and_b32 v32, v7, v8
    v_and_b32 v33, v7, v9
    v_and_b32 v34, v7, v10
    v_and_b32 v35, v7, v11
    s_waitcnt vmcnt(13)
    s_nop 0
    v_mfma_f32_16x16x32_bf16 v[24:27], v[32:35], v[72:75], v[24:27]
    v_perm_b32 v7, v20, v20, s91
    v_and_b32 v36, v7, v8
    v_and_b32 v37, v7, v9
    v_and_b32 v38, v7, v10
    v_and_b32 v39, v7, v11
    s_waitcnt vmcnt(12)
    s_nop 0
    v_mfma_f32_16x16x32_bf16 v[24:27], v[36:39], v[76:79], v[24:27]
    v_perm_b32 v7, v21, v21, s90
    v_and_b32 v32, v7, v8
    v_and_b32 v33, v7, v9
    v_and_b32 v34, v7, v10
    v_and_b32 v35, v7, v11
    s_waitcnt vmcnt(11)
    s_nop 0
    v_mfma_f32_16x16x32_bf16 v[24:27], v[32:35], v[80:83], v[24:27]
    v_perm_b32 v7, v21, v21, s91
    v_and_b32 v36, v7, v8
    v_and_b32 v37, v7, v9
    v_and_b32 v38, v7, v10
    v_and_b32 v39, v7, v11
    s_waitcnt vmcnt(10)
    s_nop 0
    v_mfma_f32_16x16x32_bf16 v[24:27], v[36:39], v[84:87], v[24:27]
    v_perm_b32 v7, v22, v22, s90
    v_and_b32 v32, v7, v8
    v_and_b32 v33, v7, v9
    v_and_b32 v34, v7, v10
    v_and_b32 v35, v7, v11
    s_waitcnt vmcnt(9)
    s_nop 0
    v_mfma_f32_16x16x32_bf16 v[24:27], v[32:35], v[88:91], v[24:27]
    v_perm_b32 v7, v22, v22, s91
    v_and_b32 v36, v7, v8
    v_and_b32 v37, v7, v9
    v_and_b32 v38, v7, v10
    v_and_b32 v39, v7, v11
    s_waitcnt vmcnt(8)
    s_nop 0
    v_mfma_f32_16x16x32_bf16 v[24:27], v[36:39], v[92:95], v[24:27]
    v_perm_b32 v7, v23, v23, s90
    v_and_b32 v32, v7, v8
    v_and_b32 v33, v7, v9
    v_and_b32 v34, v7, v10
    v_and_b32 v35, v7, v11
    s_waitcnt vmcnt(7)
    s_nop 0
    v_mfma_f32_16x16x32_bf16 v[24:27], v[32:35], v[96:99], v[24:27]
    v_perm_b32 v7, v23, v23, s91
    v_and_b32 v36, v7, v8
    v_and_b32 v37, v7, v9
    v_and_b32 v38, v7, v10
    v_and_b32 v39, v7, v11
    s_waitcnt vmcnt(6)
    s_nop 0
    v_mfma_f32_16x16x32_bf16 v[24:27], v[36:39], v[100:103], v[24:27]
    v_and_b32 v7, 15, v1
    v_lshlrev_b32 v7, 5, v7
    v_bfe_u32 v8, v1, 4, 1
    v_lshl_add_u32 v7, v8, 4, v7
    s_lshl_b32 s67, s64, 3
    s_add_u32 s67, s67, s65
    s_lshl_b32 s67, s67, 9
    s_add_u32 s67, s67, 589824
    v_add_u32 v7, s67, v7
    s_mov_b64 exec, 0xffffffff
    buffer_store_dwordx4 v[24:27], v7, s[52:55], 0 offen sc1
    s_mov_b64 exec, -1
    v_lshlrev_b32 v9, 4, v1
    global_load_dwordx4 v[12:15], v9, s[4:5]
    global_load_dwordx4 v[16:19], v9, s[8:9]
    s_waitcnt vmcnt(0)
    s_waitcnt lgkmcnt(0)
    s_lshl_b32 s67, s64, 3
    v_mov_b32 v10, s67
    v_mov_b32 v11, 1
    s_mov_b64 exec, 1
    global_atomic_add v28, v10, v11, s[12:13] sc0
    s_mov_b64 exec, -1
    v_dot2_f32_bf16 v24, v12, v16, 0
    s_nop 2
    v_dot2c_f32_bf16 v24, v13, v17
    v_dot2c_f32_bf16 v24, v14, v18
    v_dot2c_f32_bf16 v24, v15, v19
    s_nop 2
    v_add_f32_dpp v24, v24, v24 row_ror:8 row_mask:0xf bank_mask:0xf
    s_nop 1
    v_add_f32_dpp v24, v24, v24 row_ror:4 row_mask:0xf bank_mask:0xf
    s_nop 1
    v_add_f32_dpp v24, v24, v24 row_ror:2 row_mask:0xf bank_mask:0xf
    s_nop 1
    v_add_f32_dpp v24, v24, v24 row_ror:1 row_mask:0xf bank_mask:0xf
    v_mov_b32 v25, v24
    s_nop 1
    v_permlane16_swap_b32 v24, v25
    s_nop 0
    v_add_f32 v24, v24, v25
    v_mov_b32 v25, v24
    s_nop 1
    v_permlane32_swap_b32 v24, v25
    s_nop 0
    v_add_f32 v24, v24, v25
    v_mul_f32 v24, 0xbfb8aa3b, v24
    v_exp_f32 v24, v24
    s_nop 0
    v_add_f32 v25, 1.0, v24
    v_rcp_f32 v25, v25
    s_nop 0
    v_mul_f32 v26, v24, v25
    v_sub_f32 v27, 1.0, v25
    v_cmp_lt_f32 vcc, 1.0, v24
    s_nop 1
    v_cndmask_b32 v26, v26, v27, vcc
    v_mov_b32 v10, 5248
    v_mov_b32 v30, v25
    v_mov_b32 v31, v26
    ds_write_b64 v10, v[30:31]
    s_waitcnt vmcnt(0)
    v_readfirstlane_b32 s67, v28
    s_and_b32 s67, s67, 7
    s_cmp_eq_u32 s67, 7
    s_cbranch_scc0 L_qpoll
    s_lshl_b32 s67, s64, 12
    s_add_u32 s67, s67, 589824
    v_lshlrev_b32 v10, 4, v1
    v_add_u32 v10, s67, v10
    buffer_load_dwordx4 v[40:43], v10, s[52:55], 0 offen offset:0 sc1
    buffer_load_dwordx4 v[44:47], v10, s[52:55], 0 offen offset:1024 sc1
    buffer_load_dwordx4 v[48:51], v10, s[52:55], 0 offen offset:2048 sc1
    buffer_load_dwordx4 v[52:55], v10, s[52:55], 0 offen offset:3072 sc1
    s_lshl_b32 s67, s64, 11
    s_add_u32 s67, s67, 851968
    v_lshlrev_b32 v10, 3, v1
    v_add_u32 v10, s67, v10
    s_waitcnt vmcnt(0)
    v_add_f32 v40, v40, v44
    v_add_f32 v41, v41, v45
    v_add_f32 v42, v42, v46
    v_add_f32 v43, v43, v47
    v_add_f32 v48, v48, v52
    v_add_f32 v49, v49, v53
    v_add_f32 v50, v50, v54
    v_add_f32 v51, v51, v55
    v_add_f32 v40, v40, v48
    v_add_f32 v41, v41, v49
    v_add_f32 v42, v42, v50
    v_add_f32 v43, v43, v51
    v_mov_b32 v44, v40
    v_mov_b32 v45, v41
    v_mov_b32 v46, v42
    v_mov_b32 v47, v43
    v_permlane32_swap_b32 v40, v44
    v_permlane32_swap_b32 v41, v45
    v_permlane32_swap_b32 v42, v46
    v_permlane32_swap_b32 v43, v47
    v_add_f32 v40, v40, v44
    v_add_f32 v41, v41, v45
    v_add_f32 v42, v42, v46
    v_add_f32 v43, v43, v47
    v_cvt_pk_bf16_f32 v44, v40, v41
    v_cvt_pk_bf16_f32 v45, v42, v43
    v_min_u32 v44, -2, v44
    v_min_u32 v45, -2, v45
    buffer_store_dwordx2 v[44:45], v10, s[52:55], 0 offen offset:0 sc1
    buffer_store_dwordx2 v[44:45], v10, s[52:55], 0 offen offset:512 sc1
    buffer_store_dwordx2 v[44:45], v10, s[52:55], 0 offen offset:1024 sc1
    buffer_store_dwordx2 v[44:45], v10, s[52:55], 0 offen offset:1536 sc1
    s_branch L_qdone
L_qpoll:
    s_mov_b32 s67, 0
L_qp:
    buffer_load_dwordx2 v[44:45], v6, s[52:55], 0 offen sc1
    s_waitcnt vmcnt(0)
    v_max_u32 v11, v44, v45
    v_cmp_eq_u32 vcc, -1, v11
    s_add_u32 s67, s67, 1
    s_cmp_gt_u32 s67, 65536
    s_cbranch_scc1 L_qdone
    s_cbranch_vccz L_qdone
    s_sleep 2
    s_branch L_qp
L_qdone:
    v_and_b32 v10, 31, v1
    v_lshlrev_b32 v10, 3, v10
    ds_write_b64 v10, v[44:45] offset:4352
    s_waitcnt lgkmcnt(0)
    s_barrier
    s_cmp_eq_u32 s69, 1
    s_cselect_b32 s58, 1409024, 0
    s_mov_b32 s59, 0x20000
    s_mov_b32 s62, s58
    s_mov_b32 s63, 0x20000
    s_and_b32 s67, s66, 3
    s_lshl_b32 s67, s67, 7
    v_lshrrev_b32 v7, 2, v1
    v_add_u32 v7, s67, v7
    v_lshlrev_b32 v9, 1, v7
    v_mul_u32_u24 v8, 2752, v7
    v_and_b32 v7, 3, v1
    v_lshl_add_u32 v8, v7, 4, v8
    s_lshr_b32 s67, s66, 2
    s_lshl_b32 s67, s67, 6
    v_add_u32 v8, s67, v8
    global_load_ushort v12, v9, s[4:5] offset:0
    global_load_ushort v13, v9, s[4:5] offset:32
    global_load_ushort v14, v9, s[4:5] offset:64
    global_load_ushort v15, v9, s[4:5] offset:96
    global_load_ushort v16, v9, s[4:5] offset:128
    global_load_ushort v17, v9, s[4:5] offset:160
    global_load_ushort v18, v9, s[4:5] offset:192
    global_load_ushort v19, v9, s[4:5] offset:224
    buffer_load_dwordx4 v[40:43], v8, s[56:59], 0 offen nt
    buffer_load_dwordx4 v[44:47], v8, s[60:63], 0 offen nt
    v_add_u32 v8, 44032, v8
    buffer_load_dwordx4 v[48:51], v8, s[56:59], 0 offen nt
    buffer_load_dwordx4 v[52:55], v8, s[60:63], 0 offen nt
    v_add_u32 v8, 44032, v8
    buffer_load_dwordx4 v[56:59], v8, s[56:59], 0 offen nt
    buffer_load_dwordx4 v[60:63], v8, s[60:63], 0 offen nt
    v_add_u32 v8, 44032, v8
    v_mov_b32 v104, 0
    v_mov_b32 v105, 0
    v_mov_b32 v106, 0
    v_mov_b32 v107, 0
    v_mov_b32 v108, 0
    v_mov_b32 v109, 0
    v_mov_b32 v110, 0
    v_mov_b32 v111, 0
    v_mov_b32 v112, 0
    v_mov_b32 v113, 0
    v_mov_b32 v114, 0
    v_mov_b32 v115, 0
    v_mov_b32 v116, 0
    v_mov_b32 v117, 0
    v_mov_b32 v118, 0
    v_mov_b32 v119, 0
    s_waitcnt vmcnt(4)
    buffer_load_dwordx4 v[64:67], v8, s[56:59], 0 offen nt
    buffer_load_dwordx4 v[68:71], v8, s[60:63], 0 offen nt
    v_add_u32 v8, 44032, v8
    v_lshlrev_b32 v25, 16, v12
    v_dot2c_f32_bf16 v104, v40, v12
    v_dot2c_f32_bf16 v105, v40, v25
    v_dot2c_f32_bf16 v112, v44, v12
    v_dot2c_f32_bf16 v113, v44, v25
    v_dot2c_f32_bf16 v106, v41, v12
    v_dot2c_f32_bf16 v107, v41, v25
    v_dot2c_f32_bf16 v114, v45, v12
    v_dot2c_f32_bf16 v115, v45, v25
    v_dot2c_f32_bf16 v108, v42, v12
    v_dot2c_f32_bf16 v109, v42, v25
    v_dot2c_f32_bf16 v116, v46, v12
    v_dot2c_f32_bf16 v117, v46, v25
    v_dot2c_f32_bf16 v110, v43, v12
    v_dot2c_f32_bf16 v111, v43, v25
    v_dot2c_f32_bf16 v118, v47, v12
    v_dot2c_f32_bf16 v119, v47, v25
    s_waitcnt vmcnt(4)
    buffer_load_dwordx4 v[72:75], v8, s[56:59], 0 offen nt
    buffer_load_dwordx4 v[76:79], v8, s[60:63], 0 offen nt
    v_add_u32 v8, 44032, v8
    v_lshlrev_b32 v25, 16, v13
    v_dot2c_f32_bf16 v104, v48, v13
    v_dot2c_f32_bf16 v105, v48, v25
    v_dot2c_f32_bf16 v112, v52, v13
    v_dot2c_f32_bf16 v113, v52, v25
    v_dot2c_f32_bf16 v106, v49, v13
    v_dot2c_f32_bf16 v107, v49, v25
    v_dot2c_f32_bf16 v114, v53, v13
    v_dot2c_f32_bf16 v115, v53, v25
    v_dot2c_f32_bf16 v108, v50, v13
    v_dot2c_f32_bf16 v109, v50, v25
    v_dot2c_f32_bf16 v116, v54, v13
    v_dot2c_f32_bf16 v117, v54, v25
    v_dot2c_f32_bf16 v110, v51, v13
    v_dot2c_f32_bf16 v111, v51, v25
    v_dot2c_f32_bf16 v118, v55, v13
    v_dot2c_f32_bf16 v119, v55, v25
    s_waitcnt vmcnt(4)
    buffer_load_dwordx4 v[80:83], v8, s[56:59], 0 offen nt
    buffer_load_dwordx4 v[84:87], v8, s[60:63], 0 offen nt
    v_add_u32 v8, 44032, v8
    v_lshlrev_b32 v25, 16, v14
    v_dot2c_f32_bf16 v104, v56, v14
    v_dot2c_f32_bf16 v105, v56, v25
    v_dot2c_f32_bf16 v112, v60, v14
    v_dot2c_f32_bf16 v113, v60, v25
    v_dot2c_f32_bf16 v106, v57, v14
    v_dot2c_f32_bf16 v107, v57, v25
    v_dot2c_f32_bf16 v114, v61, v14
    v_dot2c_f32_bf16 v115, v61, v25
    v_dot2c_f32_bf16 v108, v58, v14
    v_dot2c_f32_bf16 v109, v58, v25
    v_dot2c_f32_bf16 v116, v62, v14
    v_dot2c_f32_bf16 v117, v62, v25
    v_dot2c_f32_bf16 v110, v59, v14
    v_dot2c_f32_bf16 v111, v59, v25
    v_dot2c_f32_bf16 v118, v63, v14
    v_dot2c_f32_bf16 v119, v63, v25
    s_waitcnt vmcnt(4)
    buffer_load_dwordx4 v[88:91], v8, s[56:59], 0 offen nt
    buffer_load_dwordx4 v[92:95], v8, s[60:63], 0 offen nt
    v_add_u32 v8, 44032, v8
    v_lshlrev_b32 v25, 16, v15
    v_dot2c_f32_bf16 v104, v64, v15
    v_dot2c_f32_bf16 v105, v64, v25
    v_dot2c_f32_bf16 v112, v68, v15
    v_dot2c_f32_bf16 v113, v68, v25
    v_dot2c_f32_bf16 v106, v65, v15
    v_dot2c_f32_bf16 v107, v65, v25
    v_dot2c_f32_bf16 v114, v69, v15
    v_dot2c_f32_bf16 v115, v69, v25
    v_dot2c_f32_bf16 v108, v66, v15
    v_dot2c_f32_bf16 v109, v66, v25
    v_dot2c_f32_bf16 v116, v70, v15
    v_dot2c_f32_bf16 v117, v70, v25
    v_dot2c_f32_bf16 v110, v67, v15
    v_dot2c_f32_bf16 v111, v67, v25
    v_dot2c_f32_bf16 v118, v71, v15
    v_dot2c_f32_bf16 v119, v71, v25
    s_waitcnt vmcnt(4)
    buffer_load_dwordx4 v[96:99], v8, s[56:59], 0 offen nt
    buffer_load_dwordx4 v[100:103], v8, s[60:63], 0 offen nt
    v_lshlrev_b32 v25, 16, v16
    v_dot2c_f32_bf16 v104, v72, v16
    v_dot2c_f32_bf16 v105, v72, v25
    v_dot2c_f32_bf16 v112, v76, v16
    v_dot2c_f32_bf16 v113, v76, v25
    v_dot2c_f32_bf16 v106, v73, v16
    v_dot2c_f32_bf16 v107, v73, v25
    v_dot2c_f32_bf16 v114, v77, v16
    v_dot2c_f32_bf16 v115, v77, v25
    v_dot2c_f32_bf16 v108, v74, v16
    v_dot2c_f32_bf16 v109, v74, v25
    v_dot2c_f32_bf16 v116, v78, v16
    v_dot2c_f32_bf16 v117, v78, v25
    v_dot2c_f32_bf16 v110, v75, v16
    v_dot2c_f32_bf16 v111, v75, v25
    v_dot2c_f32_bf16 v118, v79, v16
    v_dot2c_f32_bf16 v119, v79, v25
    s_waitcnt vmcnt(4)
    v_lshlrev_b32 v25, 16, v17
    v_dot2c_f32_bf16 v104, v80, v17
    v_dot2c_f32_bf16 v105, v80, v25
    v_dot2c_f32_bf16 v112, v84, v17
    v_dot2c_f32_bf16 v113, v84, v25
    v_dot2c_f32_bf16 v106, v81, v17
    v_dot2c_f32_bf16 v107, v81, v25
    v_dot2c_f32_bf16 v114, v85, v17
    v_dot2c_f32_bf16 v115, v85, v25
    v_dot2c_f32_bf16 v108, v82, v17
    v_dot2c_f32_bf16 v109, v82, v25
    v_dot2c_f32_bf16 v116, v86, v17
    v_dot2c_f32_bf16 v117, v86, v25
    v_dot2c_f32_bf16 v110, v83, v17
    v_dot2c_f32_bf16 v111, v83, v25
    v_dot2c_f32_bf16 v118, v87, v17
    v_dot2c_f32_bf16 v119, v87, v25
    s_waitcnt vmcnt(2)
    v_lshlrev_b32 v25, 16, v18
    v_dot2c_f32_bf16 v104, v88, v18
    v_dot2c_f32_bf16 v105, v88, v25
    v_dot2c_f32_bf16 v112, v92, v18
    v_dot2c_f32_bf16 v113, v92, v25
    v_dot2c_f32_bf16 v106, v89, v18
    v_dot2c_f32_bf16 v107, v89, v25
    v_dot2c_f32_bf16 v114, v93, v18
    v_dot2c_f32_bf16 v115, v93, v25
    v_dot2c_f32_bf16 v108, v90, v18
    v_dot2c_f32_bf16 v109, v90, v25
    v_dot2c_f32_bf16 v116, v94, v18
    v_dot2c_f32_bf16 v117, v94, v25
    v_dot2c_f32_bf16 v110, v91, v18
    v_dot2c_f32_bf16 v111, v91, v25
    v_dot2c_f32_bf16 v118, v95, v18
    v_dot2c_f32_bf16 v119, v95, v25
    s_waitcnt vmcnt(0)
    v_lshlrev_b32 v25, 16, v19
    v_dot2c_f32_bf16 v104, v96, v19
    v_dot2c_f32_bf16 v105, v96, v25
    v_dot2c_f32_bf16 v112, v100, v19
    v_dot2c_f32_bf16 v113, v100, v25
    v_dot2c_f32_bf16 v106, v97, v19
    v_dot2c_f32_bf16 v107, v97, v25
    v_dot2c_f32_bf16 v114, v101, v19
    v_dot2c_f32_bf16 v115, v101, v25
    v_dot2c_f32_bf16 v108, v98, v19
    v_dot2c_f32_bf16 v109, v98, v25
    v_dot2c_f32_bf16 v116, v102, v19
    v_dot2c_f32_bf16 v117, v102, v25
    v_dot2c_f32_bf16 v110, v99, v19
    v_dot2c_f32_bf16 v111, v99, v25
    v_dot2c_f32_bf16 v118, v103, v19
    v_dot2c_f32_bf16 v119, v103, v25
    v_permlane32_swap_b32 v104, v112
    v_permlane32_swap_b32 v105, v113
    v_permlane32_swap_b32 v106, v114
    v_permlane32_swap_b32 v107, v115
    v_permlane32_swap_b32 v108, v116
    v_permlane32_swap_b32 v109, v117
    v_permlane32_swap_b32 v110, v118
    v_permlane32_swap_b32 v111, v119
    v_add_f32 v104, v104, v112
    v_add_f32 v105, v105, v113
    v_add_f32 v106, v106, v114
    v_add_f32 v107, v107, v115
    v_add_f32 v108, v108, v116
    v_add_f32 v109, v109, v117
    v_add_f32 v110, v110, v118
    v_add_f32 v111, v111, v119
    v_permlane16_swap_b32 v104, v108
    v_permlane16_swap_b32 v105, v109
    v_permlane16_swap_b32 v106, v110
    v_permlane16_swap_b32 v107, v111
    v_add_f32 v104, v104, v108
    v_add_f32 v105, v105, v109
    v_add_f32 v106, v106, v110
    v_add_f32 v107, v107, v111
    v_add_f32_dpp v24, v104, v104 row_ror:8 row_mask:0xf bank_mask:0x3
    v_add_f32_dpp v25, v105, v105 row_ror:8 row_mask:0xf bank_mask:0x3
    s_nop 0
    v_add_f32_dpp v24, v106, v106 row_ror:8 row_mask:0xf bank_mask:0xc
    v_add_f32_dpp v25, v107, v107 row_ror:8 row_mask:0xf bank_mask:0xc
    s_nop 0
    v_add_f32_dpp v26, v24, v24 row_shl:4 row_mask:0xf bank_mask:0x5
    s_nop 1
    v_add_f32_dpp v26, v25, v25 row_shr:4 row_mask:0xf bank_mask:0xa
    v_min_u32 v26, -2, v26
    s_cmp_eq_u32 s69, 1
    s_cbranch_scc0 L_nogup
    buffer_store_dword v26, v2, s[52:55], 0 offen sc1
L_nogup:
    v_mov_b32 v10, 5264
    s_mov_b32 s67, 0
L_lw:
    ds_read_b32 v11, v10
    s_waitcnt lgkmcnt(0)
    v_cmp_gt_u32 vcc, 8, v11
    s_add_u32 s67, s67, 1
    s_cmp_gt_u32 s67, 524288
    s_cbranch_scc1 L_lw_done
    s_cbranch_vccz L_lw_done
    s_sleep 4
    s_branch L_lw
L_lw_done:
    v_and_b32 v10, 7, v1
    v_lshlrev_b32 v10, 3, v10
    ds_read_b64 v[24:25], v10 offset:5120
    s_waitcnt lgkmcnt(0)
    v_mov_b32 v26, v24
    s_nop 1
    v_max_f32_dpp v26, v26, v26 quad_perm:[1,0,3,2] row_mask:0xf bank_mask:0xf
    s_nop 1
    v_max_f32_dpp v26, v26, v26 quad_perm:[2,3,0,1] row_mask:0xf bank_mask:0xf
    s_nop 1
    v_max_f32_dpp v26, v26, v26 row_half_mirror row_mask:0xf bank_mask:0xf
    v_sub_f32 v27, v24, v26
    v_exp_f32 v27, v27
    s_nop 0
    v_mul_f32 v27, v27, v25
    s_nop 1
    v_add_f32_dpp v27, v27, v27 quad_perm:[1,0,3,2] row_mask:0xf bank_mask:0xf
    s_nop 1
    v_add_f32_dpp v27, v27, v27 quad_perm:[2,3,0,1] row_mask:0xf bank_mask:0xf
    s_nop 1
    v_add_f32_dpp v27, v27, v27 row_half_mirror row_mask:0xf bank_mask:0xf
    v_min_u32 v28, -2, v26
    v_min_u32 v29, -2, v27
    s_mov_b64 exec, 1
    buffer_store_dwordx2 v[28:29], v3, s[52:55], 0 offen sc1
    s_mov_b64 exec, -1
    s_lshl_b32 s67, s64, 6
    s_add_u32 s67, s67, 524288
    v_and_b32 v10, 7, v1
    v_lshlrev_b32 v10, 3, v10
    v_add_u32 v10, s67, v10
    s_lshr_b32 s67, s66, 2
    s_lshl_b32 s67, s67, 10
    s_and_b32 s68, s66, 3
    s_lshl_b32 s68, s68, 2
    s_add_u32 s67, s67, s68
    s_add_u32 s67, s67, 786432
    v_and_b32 v11, 3, v1
    v_lshlrev_b32 v11, 8, v11
    v_lshrrev_b32 v12, 2, v1
    v_lshl_add_u32 v11, v12, 4, v11
    v_add_u32 v11, s67, v11
    s_mov_b32 s67, 0
L_ml:
    buffer_load_dwordx2 v[30:31], v10, s[52:55], 0 offen sc1
    buffer_load_dword v32, v11, s[52:55], 0 offen sc1
    s_waitcnt vmcnt(0)
    s_cmp_eq_u32 s69, 1
    s_cbranch_scc1 L_gu_ok
    v_mov_b32 v32, 0
L_gu_ok:
    v_max3_u32 v13, v30, v31, v32
    v_cmp_eq_u32 vcc, -1, v13
    s_add_u32 s67, s67, 1
    s_cmp_gt_u32 s67, 65536
    s_cbranch_scc1 L_ml_done
    s_cbranch_vccz L_ml_done
    s_sleep 16
    s_branch L_ml
L_ml_done:
    v_mov_b32 v26, v30
    s_nop 1
    v_max_f32_dpp v26, v26, v26 quad_perm:[1,0,3,2] row_mask:0xf bank_mask:0xf
    s_nop 1
    v_max_f32_dpp v26, v26, v26 quad_perm:[2,3,0,1] row_mask:0xf bank_mask:0xf
    s_nop 1
    v_max_f32_dpp v26, v26, v26 row_half_mirror row_mask:0xf bank_mask:0xf
    v_sub_f32 v27, v30, v26
    v_exp_f32 v27, v27
    s_nop 0
    v_mul_f32 v27, v27, v31
    s_nop 1
    v_add_f32_dpp v27, v27, v27 quad_perm:[1,0,3,2] row_mask:0xf bank_mask:0xf
    s_nop 1
    v_add_f32_dpp v27, v27, v27 quad_perm:[2,3,0,1] row_mask:0xf bank_mask:0xf
    s_nop 1
    v_add_f32_dpp v27, v27, v27 row_half_mirror row_mask:0xf bank_mask:0xf
    v_rcp_f32 v27, v27
    v_sub_f32 v28, v24, v26
    v_exp_f32 v28, v28
    s_nop 0
    v_mul_f32 v28, v28, v27
    v_and_b32 v10, 7, v1
    v_lshlrev_b32 v10, 2, v10
    ds_write_b32 v10, v28 offset:5184
    v_add_f32_dpp v32, v32, v32 quad_perm:[1,0,3,2] row_mask:0xf bank_mask:0xf
    s_nop 1
    v_add_f32_dpp v32, v32, v32 quad_perm:[2,3,0,1] row_mask:0xf bank_mask:0xf
    v_cvt_pk_bf16_f32 v26, v32, v32
    v_and_b32 v26, 0xffff0000, v26
    v_mov_b32 v27, v26
    s_nop 1
    v_permlane32_swap_b32 v26, v27
    s_nop 0
    v_mul_f32 v26, v26, v27
    v_cvt_pk_bf16_f32 v26, v26, v26
    v_lshrrev_b32 v10, 2, v1
    v_and_b32 v10, 7, v10
    v_lshlrev_b32 v10, 2, v10
    ds_write_b32 v10, v26 offset:5216
    s_cmp_ge_u32 s2, 32
    s_cbranch_scc1 L_nocons
    v_and_b32 v10, 31, v1
    v_lshlrev_b32 v10, 3, v10
    s_mov_b32 s67, 0
L_af:
    global_load_dword v11, v10, s[12:13] sc1
    s_waitcnt vmcnt(0)
    v_cmp_gt_u32 vcc, 8, v11
    s_add_u32 s67, s67, 1
    s_cmp_gt_u32 s67, 65536
    s_cbranch_scc1 L_nocons
    s_cbranch_vccz L_nocons
    s_sleep 16
    s_branch L_af
L_nocons:
    v_and_b32 v10, 15, v1
    v_lshlrev_b32 v10, 2, v10
    v_add_u32 v10, 5376, v10
    s_lshl_b32 s67, s2, 5
    v_and_b32 v12, 15, v1
    v_lshlrev_b32 v12, 1, v12
    v_add_u32 v12, s67, v12
    s_waitcnt lgkmcnt(0)
    s_barrier
    s_barrier
    s_cmp_ge_u32 s2, 32
    s_cbranch_scc1 L_svc_end
    s_barrier
    ds_read2_b32 v[40:41], v10 offset0:0 offset1:16
    ds_read2_b32 v[42:43], v10 offset0:32 offset1:48
    ds_read2_b32 v[44:45], v10 offset0:64 offset1:80
    ds_read2_b32 v[46:47], v10 offset0:96 offset1:112
    s_waitcnt lgkmcnt(0)
    v_add_f32 v40, v40, v44
    v_add_f32 v41, v41, v45
    v_add_f32 v42, v42, v46
    v_add_f32 v43, v43, v47
    v_add_f32 v40, v40, v42
    v_add_f32 v41, v41, v43
    v_add_f32 v40, v40, v41
    v_cvt_pk_bf16_f32 v44, v40, v40
    s_mov_b64 exec, 0xffff
    global_store_short v12, v44, s[10:11]
    s_mov_b64 exec, -1
L_svc_end:
L_end:
    s_endpgm
.section .rodata,"a"
.p2align 6
.amdhsa_kernel gated_mix__mha_block_cached__glu_gated_bilinear__decode_kernel
  .amdhsa_next_free_vgpr 168
  .amdhsa_next_free_sgpr 102
  .amdhsa_accum_offset 168
  .amdhsa_group_segment_fixed_size 0
  .amdhsa_kernarg_size 104
  .amdhsa_user_sgpr_count 2
  .amdhsa_user_sgpr_kernarg_segment_ptr 1
  .amdhsa_system_sgpr_workgroup_id_x 1
.end_amdhsa_kernel
```
